```python
import torch

def _softmax(x, axis=-1):
    return torch.softmax(x, dim=axis)
def _gelu(x):
    return torch.nn.functional.gelu(x, approximate="tanh")
def _silu(x):
    return torch.nn.functional.silu(x)
def _sigmoid(x):
    return torch.sigmoid(x)
def _layernorm(x, axis=-1, eps=1e-5):
    m = x.mean(dim=axis, keepdim=True)
    v = x.var(dim=axis, keepdim=True, unbiased=False)
    return (x - m) / torch.sqrt(v + eps)
def _scatter_add(tgt, idx, src, axis=0):
    return tgt.clone().index_add_(axis, idx, src)
def _segment_sum(src, seg, n):
    out = torch.zeros((n,) + src.shape[1:], dtype=src.dtype)
    return out.index_add_(0, seg, src)
def _pad(x, pw):
    flat = tuple(v for pair in reversed(pw) for v in pair)
    return torch.nn.functional.pad(x, flat)

kernel_name = 'gated_mix__ssm_conv_h3__dense_activation_gelu__prompt'

def setup_inputs():

    _w = (lambda a: (lambda t: t.to(torch.bfloat16) if t.is_floating_point() else t)(torch.as_tensor(a)))
    def _A_setup():
        B, S, D = 1, 2048, 576
        ks = 4
        return {
            "q": _w((lambda *s: torch.randn(*s, dtype=torch.bfloat16) * 0.05)(B, S, D)),
            "k": _w((lambda *s: torch.randn(*s, dtype=torch.bfloat16) * 0.4)(B, S, D)),
            "v": _w((lambda *s: torch.randn(*s, dtype=torch.bfloat16) * 0.2)(B, S, D)),
            "shift_k": _w((lambda *s: torch.randn(*s, dtype=torch.bfloat16) * 0.4)(D, ks) * 0.5),
            "ssm_k": _w((lambda *s: torch.randn(*s, dtype=torch.bfloat16) * 0.4)(D, S) * (1.0 / S ** 0.5)),
            "ssm_D": _w((lambda *s: torch.randn(*s, dtype=torch.bfloat16) * 0.2)(D)),
        }
    _A_in = _A_setup()

    def _B_setup():
        B, S, D, F = 1, 2048, 576, 4608
        return {
            "x": _w((lambda *s: torch.randn(*s, dtype=torch.bfloat16) * 0.05)(B, S, D)),
            "w1": _w((lambda *s: torch.randn(*s, dtype=torch.bfloat16) * 3.2)(D, F) * (D ** -0.5)),
            "b1": _w((lambda *s: torch.randn(*s, dtype=torch.bfloat16) * 3.2)(F) * 0.01),
            "w2": _w((lambda *s: torch.randn(*s, dtype=torch.bfloat16) * 0.05)(F, D) * (F ** -0.5)),
            "b2": _w((lambda *s: torch.randn(*s, dtype=torch.bfloat16) * 0.1)(D) * 0.01),
        }
    _B_in = _B_setup()

    return {
        "A_q": _A_in["q"],
        "A_k": _A_in["k"],
        "A_v": _A_in["v"],
        "A_shift_k": _A_in["shift_k"],
        "A_ssm_k": _A_in["ssm_k"],
        "A_ssm_D": _A_in["ssm_D"],
        "B_x": _B_in["x"],
        "B_w1": _B_in["w1"],
        "B_b1": _B_in["b1"],
        "B_w2": _B_in["w2"],
        "B_b2": _B_in["b2"],
        "gate_w": _w((lambda *s: torch.randn(*s, dtype=torch.bfloat16) * 0.05)(576) * 16.0),
    }

def reference(A_q, A_k, A_v, A_shift_k, A_ssm_k, A_ssm_D, B_x, B_w1, B_b1, B_w2, B_b2, gate_w):
    def _A_ref(q, k, v, shift_k, ssm_k, ssm_D):
        B, S, D = q.shape
        ks = shift_k.shape[-1]
        k_pad = _pad(k, ((0, 0), (ks - 1, 0), (0, 0)))
        k_shift = torch.zeros_like(k)
        for t in range(ks):
            k_shift = k_shift + k_pad[:, t:t + S, :] * shift_k[:, ks - 1 - t][None, None, :]
        kv = k_shift * v
        L = 2 * S
        kv_pad = _pad(kv, ((0, 0), (0, S), (0, 0)))
        kf_pad = _pad(ssm_k, ((0, 0), (0, S)))
        kv_f = (lambda x, axes=(-2,-1): torch.fft.rfft2(x.float(), dim=axes))(kv_pad[:, None, :, :], axes=(1, 2))
        kf_f = (lambda x, axes=(-2,-1): torch.fft.rfft2(x.float(), dim=axes))(kf_pad[:, None, :], axes=(1, 2))
        kf_f = (lambda x, *d: x.permute(*d))(kf_f, 1, 2, 0)
        y_f = kv_f * kf_f[None, :, :, :]
        y = (lambda x, s, axes=(-2,-1): torch.fft.irfft2(x, s=s, dim=axes).to(torch.bfloat16))(y_f, (1, L), axes=(1, 2))[:, 0, :S, :]
        y = y + kv * ssm_D[None, None, :]
        return q * y

    def _B_ref(x, w1, b1, w2, b2):
        h = torch.einsum("bsd,df->bsf", x, w1) + b1
        h = _gelu(h)
        return torch.einsum("bsf,fd->bsd", h, w2) + b2

    x = A_q
    g = _sigmoid((x * gate_w).sum(-1, keepdims=True))
    a = _A_ref(x, A_k, A_v, A_shift_k, A_ssm_k, A_ssm_D)
    b = _B_ref(x, B_w1, B_b1, B_w2, B_b2)
    return g * a + (1 - g) * b
```

```asm
; @launch grid=(256,1,1) block=(512,1,1) lds=163840
.amdgcn_target "amdgcn-amd-amdhsa--gfx950"
.text
.p2align 8
.globl gated_mix__ssm_conv_h3__dense_activation_gelu__prompt_kernel
.type gated_mix__ssm_conv_h3__dense_activation_gelu__prompt_kernel,@function
gated_mix__ssm_conv_h3__dense_activation_gelu__prompt_kernel:
    s_cmp_ge_u32 s2, 192
    s_cbranch_scc0 Lk1_ffn
    s_cmp_ge_u32 s2, 256
    s_cbranch_scc1 Lk1_exit
    s_branch Lk1_ssm
Lk1_exit:
    s_endpgm
Lk1_ffn:
    s_and_b32 s40, s2, 7
    s_lshr_b32 s41, s2, 3
    s_lshr_b32 s42, s40, 1
    s_mul_i32 s42, s42, 3
    s_lshr_b32 s43, s41, 3
    s_add_u32 s31, s42, s43
    s_and_b32 s42, s40, 1
    s_lshl_b32 s42, s42, 3
    s_and_b32 s43, s41, 7
    s_add_u32 s32, s42, s43
    s_load_dwordx2 s[16:17], s[0:1], 0
    s_load_dwordx2 s[8:9], s[0:1], 56
    s_load_dwordx2 s[24:25], s[0:1], 64
    s_load_dwordx2 s[12:13], s[0:1], 72
    s_load_dwordx2 s[20:21], s[0:1], 112
    s_load_dwordx2 s[68:69], s[0:1], 104
    s_load_dwordx2 s[4:5], s[0:1], 96
    s_load_dwordx2 s[6:7], s[0:1], 80
    v_and_b32 v1, 63, v0
    v_lshrrev_b32 v13, 6, v0
    s_nop 0
    v_readfirstlane_b32 s28, v13
    s_mov_b32 s10, 5308416
    s_mov_b32 s11, 0x00020000
    s_mov_b32 s14, 5308416
    s_mov_b32 s15, 0x00020000
    s_mov_b32 s18, 2359296
    s_mov_b32 s19, 0x00020000
    s_mov_b32 s22, 33759232
    s_mov_b32 s23, 0x00020000
    s_mov_b32 s26, 9216
    s_mov_b32 s27, 0x00020000
    s_mov_b32 s70, 256
    s_mov_b32 s71, 0x00020000
    s_mov_b32 s37, 0xbdd2d3e8
    v_mov_b32 v9, 0xc0135761
    s_and_b32 s29, s28, 3
    s_lshr_b32 s30, s28, 2
    v_lshrrev_b32 v13, 3, v1
    v_lshrrev_b32 v14, 4, v1
    v_and_b32 v15, 7, v1
    v_xor_b32 v16, v15, v14
    v_mul_u32_u24 v17, 1152, v13
    v_lshl_add_u32 v32, v16, 4, v17
    v_xor_b32 v16, 4, v16
    v_lshl_add_u32 v33, v16, 4, v17
    v_add_u32 v33, 9216, v33
    s_lshl_b32 s41, s32, 7
    s_lshl_b32 s42, s28, 4
    s_add_u32 s41, s41, s42
    s_mul_i32 s34, s41, 1152
    s_lshl_b32 s35, s28, 11
    v_and_b32 v14, 1, v14
    v_lshlrev_b32 v14, 2, v14
    v_xor_b32 v15, v15, v14
    v_lshlrev_b32 v15, 4, v15
    v_mul_u32_u24 v14, 9216, v13
    v_add_u32 v6, v14, v15
    v_add_u32 v7, v17, v15
    s_and_b32 s43, s32, 7
    s_sub_u32 s42, s43, 5
    s_min_u32 s39, s43, s42
    s_mul_i32 s40, s31, 384
    s_lshl_b32 s41, s40, 1
    s_mul_i32 s42, s28, 221184
    s_add_u32 s33, s41, s42
    s_mov_b32 s44, s33
    s_add_u32 s42, s39, 0
    s_sub_u32 s41, s42, 5
    s_min_u32 s42, s42, s41
    s_add_u32 s42, s42, 1
    s_lshl_b32 s42, s42, 7
    s_add_u32 s45, s33, s42
    s_add_u32 s42, s39, 1
    s_sub_u32 s41, s42, 5
    s_min_u32 s42, s42, s41
    s_add_u32 s42, s42, 1
    s_lshl_b32 s42, s42, 7
    s_add_u32 s46, s33, s42
    s_add_u32 s42, s39, 2
    s_sub_u32 s41, s42, 5
    s_min_u32 s42, s42, s41
    s_add_u32 s42, s42, 1
    s_lshl_b32 s42, s42, 7
    s_add_u32 s47, s33, s42
    s_add_u32 s42, s39, 3
    s_sub_u32 s41, s42, 5
    s_min_u32 s42, s42, s41
    s_add_u32 s42, s42, 1
    s_lshl_b32 s42, s42, 7
    s_add_u32 s48, s33, s42
    s_add_u32 s42, s39, 4
    s_sub_u32 s41, s42, 5
    s_min_u32 s42, s42, s41
    s_add_u32 s42, s42, 1
    s_lshl_b32 s42, s42, 7
    s_add_u32 s49, s33, s42
    s_waitcnt lgkmcnt(0)
    s_and_b32 s9, s9, 0xffff
    s_and_b32 s13, s13, 0xffff
    s_and_b32 s17, s17, 0xffff
    s_and_b32 s21, s21, 0xffff
    s_and_b32 s25, s25, 0xffff
    s_and_b32 s69, s69, 0xffff
    s_mul_i32 s65, s28, 3072
    s_add_u32 m0, s35, 0
    s_add_u32 s36, s34, 0
    buffer_load_dwordx4 v32, s[16:19], s36 offen lds
    s_add_u32 m0, s35, 1024
    s_add_u32 s36, s34, 0
    buffer_load_dwordx4 v33, s[16:19], s36 offen lds
    s_add_u32 m0, s35, 16384
    s_add_u32 s36, s34, 128
    buffer_load_dwordx4 v32, s[16:19], s36 offen lds
    s_add_u32 m0, s35, 17408
    s_add_u32 s36, s34, 128
    buffer_load_dwordx4 v33, s[16:19], s36 offen lds
    s_add_u32 m0, s35, 32768
    s_add_u32 s36, s34, 256
    buffer_load_dwordx4 v32, s[16:19], s36 offen lds
    s_add_u32 m0, s35, 33792
    s_add_u32 s36, s34, 256
    buffer_load_dwordx4 v33, s[16:19], s36 offen lds
    v_lshrrev_b32 v13, 5, v1
    s_lshl_b32 s42, s28, 1
    v_add_u32 v13, s42, v13
    v_cmp_eq_u32 vcc, 0, v13
    s_sub_u32 s42, s39, 1
    v_add_u32 v13, s42, v13
    v_subrev_u32 v14, 5, v13
    v_min_u32 v13, v13, v14
    v_add_u32 v13, 1, v13
    v_mov_b32 v14, 0
    v_cndmask_b32 v13, v13, v14, vcc
    v_lshlrev_b32 v13, 7, v13
    v_and_b32 v14, 31, v1
    v_lshl_add_u32 v13, v14, 2, v13
    s_lshl_b32 s41, s40, 1
    s_cmp_lt_u32 s28, 3
    s_cbranch_scc0 Lffn_nobias_ld
    buffer_load_dword v34, v13, s[24:27], s41 offen
Lffn_nobias_ld:
    s_add_u32 m0, s65, 49152
    s_add_u32 s36, s44, 0
    buffer_load_dwordx4 v6, s[8:11], s36 offen  lds
    s_add_u32 m0, s65, 50176
    s_add_u32 s36, s44, 73728
    buffer_load_dwordx4 v6, s[8:11], s36 offen  lds
    s_add_u32 m0, s65, 51200
    s_add_u32 s36, s44, 147456
    buffer_load_dwordx4 v6, s[8:11], s36 offen  lds
    s_add_u32 m0, s65, 73728
    s_add_u32 s36, s44, 1769472
    buffer_load_dwordx4 v6, s[8:11], s36 offen  lds
    s_add_u32 m0, s65, 74752
    s_add_u32 s36, s44, 1843200
    buffer_load_dwordx4 v6, s[8:11], s36 offen  lds
    s_add_u32 m0, s65, 75776
    s_add_u32 s36, s44, 1916928
    buffer_load_dwordx4 v6, s[8:11], s36 offen  lds
    s_mul_i32 s41, s28, 24
    s_add_u32 s41, s41, 0
    s_lshr_b32 s42, s41, 6
    s_and_b32 s41, s41, 63
    s_add_u32 s41, s41, s40
    s_add_u32 s36, s42, 0
    s_add_u32 s38, s36, s39
    s_sub_u32 s38, s38, 1
    s_sub_u32 s66, s38, 5
    s_min_u32 s38, s38, s66
    s_add_u32 s38, s38, 1
    s_cmp_eq_u32 s36, 0
    s_cselect_b32 s36, 0, s38
    s_lshl_b32 s36, s36, 6
    s_add_u32 s36, s36, s41
    s_mul_i32 s50, s36, 1152
    s_add_u32 s36, s42, 3
    s_add_u32 s38, s36, s39
    s_sub_u32 s38, s38, 1
    s_sub_u32 s66, s38, 5
    s_min_u32 s38, s38, s66
    s_add_u32 s38, s38, 1
    s_cmp_eq_u32 s36, 0
    s_cselect_b32 s36, 0, s38
    s_lshl_b32 s36, s36, 6
    s_add_u32 s36, s36, s41
    s_mul_i32 s53, s36, 1152
    s_mul_i32 s41, s28, 24
    s_add_u32 s41, s41, 8
    s_lshr_b32 s42, s41, 6
    s_and_b32 s41, s41, 63
    s_add_u32 s41, s41, s40
    s_add_u32 s36, s42, 0
    s_add_u32 s38, s36, s39
    s_sub_u32 s38, s38, 1
    s_sub_u32 s66, s38, 5
    s_min_u32 s38, s38, s66
    s_add_u32 s38, s38, 1
    s_cmp_eq_u32 s36, 0
    s_cselect_b32 s36, 0, s38
    s_lshl_b32 s36, s36, 6
    s_add_u32 s36, s36, s41
    s_mul_i32 s51, s36, 1152
    s_add_u32 s36, s42, 3
    s_add_u32 s38, s36, s39
    s_sub_u32 s38, s38, 1
    s_sub_u32 s66, s38, 5
    s_min_u32 s38, s38, s66
    s_add_u32 s38, s38, 1
    s_cmp_eq_u32 s36, 0
    s_cselect_b32 s36, 0, s38
    s_lshl_b32 s36, s36, 6
    s_add_u32 s36, s36, s41
    s_mul_i32 s54, s36, 1152
    s_mul_i32 s41, s28, 24
    s_add_u32 s41, s41, 16
    s_lshr_b32 s42, s41, 6
    s_and_b32 s41, s41, 63
    s_add_u32 s41, s41, s40
    s_add_u32 s36, s42, 0
    s_add_u32 s38, s36, s39
    s_sub_u32 s38, s38, 1
    s_sub_u32 s66, s38, 5
    s_min_u32 s38, s38, s66
    s_add_u32 s38, s38, 1
    s_cmp_eq_u32 s36, 0
    s_cselect_b32 s36, 0, s38
    s_lshl_b32 s36, s36, 6
    s_add_u32 s36, s36, s41
    s_mul_i32 s52, s36, 1152
    s_add_u32 s36, s42, 3
    s_add_u32 s38, s36, s39
    s_sub_u32 s38, s38, 1
    s_sub_u32 s66, s38, 5
    s_min_u32 s38, s38, s66
    s_add_u32 s38, s38, 1
    s_cmp_eq_u32 s36, 0
    s_cselect_b32 s36, 0, s38
    s_lshl_b32 s36, s36, 6
    s_add_u32 s36, s36, s41
    s_mul_i32 s55, s36, 1152
    s_add_u32 s42, s43, 0
    s_sub_u32 s41, s42, 9
    s_min_u32 s42, s42, s41
    s_lshl_b32 s56, s42, 7
    s_add_u32 s42, s43, 1
    s_sub_u32 s41, s42, 9
    s_min_u32 s42, s42, s41
    s_lshl_b32 s57, s42, 7
    s_add_u32 s42, s43, 2
    s_sub_u32 s41, s42, 9
    s_min_u32 s42, s42, s41
    s_lshl_b32 s58, s42, 7
    s_add_u32 s42, s43, 3
    s_sub_u32 s41, s42, 9
    s_min_u32 s42, s42, s41
    s_lshl_b32 s59, s42, 7
    s_add_u32 s42, s43, 4
    s_sub_u32 s41, s42, 9
    s_min_u32 s42, s42, s41
    s_lshl_b32 s60, s42, 7
    s_add_u32 s42, s43, 5
    s_sub_u32 s41, s42, 9
    s_min_u32 s42, s42, s41
    s_lshl_b32 s61, s42, 7
    s_add_u32 s42, s43, 6
    s_sub_u32 s41, s42, 9
    s_min_u32 s42, s42, s41
    s_lshl_b32 s62, s42, 7
    s_add_u32 s42, s43, 7
    s_sub_u32 s41, s42, 9
    s_min_u32 s42, s42, s41
    s_lshl_b32 s63, s42, 7
    s_add_u32 s42, s43, 8
    s_sub_u32 s41, s42, 9
    s_min_u32 s42, s42, s41
    s_lshl_b32 s64, s42, 7
    s_lshl_b32 s42, s32, 2
    s_add_u32 s42, s42, s29
    s_mul_i32 s42, s42, 18
    s_add_u32 s42, s42, s30
    s_mul_i32 s42, s42, 12
    s_add_u32 s42, s42, s31
    s_lshl_b32 s38, s42, 11
    s_add_u32 s38, s38, 0
    s_mul_i32 s42, s32, 108
    s_add_u32 s42, s42, s31
    s_lshl_b32 s42, s42, 8
    s_add_u32 s42, s42, 33038336
    s_cmp_eq_u32 s28, 0
    s_cselect_b32 s67, s42, 0x70000000
    v_lshrrev_b32 v15, 5, v1
    s_lshl_b32 s42, s30, 7
    s_add_u32 s42, s42, 147456
    v_lshl_add_u32 v8, v15, 4, s42
    v_and_b32 v13, 15, v1
    v_lshrrev_b32 v14, 2, v13
    v_lshrrev_b32 v0, 3, v13
    v_xor_b32 v0, s30, v0
    v_lshlrev_b32 v0, 6, v0
    v_lshrrev_b32 v2, 4, v1
    v_and_b32 v2, 1, v2
    v_lshl_add_u32 v0, v2, 5, v0
    v_and_b32 v2, 3, v13
    v_lshl_add_u32 v0, v2, 3, v0
    v_lshl_add_u32 v2, v15, 3, v14
    v_lshl_add_u32 v4, v2, 7, v0
    v_lshl_add_u32 v2, v15, 2, v14
    v_lshl_add_u32 v5, v2, 7, v0
    v_and_b32 v13, 31, v1
    v_lshrrev_b32 v14, 1, v13
    v_and_b32 v14, 7, v14
    v_xor_b32 v14, v14, v15
    v_lshlrev_b32 v14, 4, v14
    s_lshl_b32 s42, s29, 12
    v_lshl_add_u32 v13, v13, 7, v14
    v_add_u32 v10, s42, v13
    s_waitcnt vmcnt(6)
    s_barrier
    v_xor_b32 v13, 0, v10
    v_xor_b32 v14, 32, v10
    v_xor_b32 v15, 64, v10
    v_xor_b32 v0, 96, v10
    ds_read_b128 v[112:115], v13 offset:0
    ds_read_b128 v[116:119], v14 offset:0
    ds_read_b128 v[120:123], v15 offset:0
    ds_read_b128 v[124:127], v0 offset:0
    ds_read_b128 v[128:131], v13 offset:16384
    ds_read_b128 v[132:135], v14 offset:16384
    ds_read_b128 v[136:139], v15 offset:16384
    ds_read_b128 v[140:143], v0 offset:16384
    ds_read_b128 v[144:147], v13 offset:32768
    ds_read_b128 v[148:151], v14 offset:32768
    ds_read_b128 v[152:155], v15 offset:32768
    ds_read_b128 v[156:159], v0 offset:32768
    s_add_u32 m0, s35, 98304
    s_add_u32 s36, s34, 384
    buffer_load_dwordx4 v32, s[16:19], s36 offen lds
    s_add_u32 m0, s35, 99328
    s_add_u32 s36, s34, 384
    buffer_load_dwordx4 v33, s[16:19], s36 offen lds
    s_add_u32 m0, s35, 114688
    s_add_u32 s36, s34, 512
    buffer_load_dwordx4 v32, s[16:19], s36 offen lds
    s_add_u32 m0, s35, 115712
    s_add_u32 s36, s34, 512
    buffer_load_dwordx4 v33, s[16:19], s36 offen lds
    s_add_u32 m0, s35, 131072
    s_add_u32 s36, s34, 640
    buffer_load_dwordx4 v32, s[16:19], s36 offen lds
    s_add_u32 m0, s35, 132096
    s_add_u32 s36, s34, 640
    buffer_load_dwordx4 v33, s[16:19], s36 offen lds
    s_waitcnt vmcnt(11)
    s_cmp_lt_u32 s28, 3
    s_cbranch_scc0 Lffn_nobias_st
    v_lshlrev_b32 v36, 16, v34
    v_and_b32 v37, 0xffff0000, v34
    v_lshlrev_b32 v35, 3, v1
    s_lshl_b32 s42, s28, 9
    s_add_u32 s42, s42, 147456
    v_add_u32 v35, s42, v35
    ds_write_b64 v35, v[36:37]
Lffn_nobias_st:
    s_waitcnt lgkmcnt(0)
    s_waitcnt vmcnt(6)
    s_barrier
    s_add_u32 m0, s35, 0
    s_add_u32 s36, s34, 768
    buffer_load_dwordx4 v32, s[16:19], s36 offen lds
    s_add_u32 m0, s35, 1024
    s_add_u32 s36, s34, 768
    buffer_load_dwordx4 v33, s[16:19], s36 offen lds
    s_add_u32 m0, s35, 16384
    s_add_u32 s36, s34, 896
    buffer_load_dwordx4 v32, s[16:19], s36 offen lds
    s_add_u32 m0, s35, 17408
    s_add_u32 s36, s34, 896
    buffer_load_dwordx4 v33, s[16:19], s36 offen lds
    s_add_u32 m0, s35, 32768
    s_add_u32 s36, s34, 1024
    buffer_load_dwordx4 v32, s[16:19], s36 offen lds
    s_add_u32 m0, s35, 33792
    s_add_u32 s36, s34, 1024
    buffer_load_dwordx4 v33, s[16:19], s36 offen lds
    ds_read_b128 v[32:35], v8 offset:0
    ds_read_b128 v[36:39], v8 offset:32
    ds_read_b128 v[40:43], v8 offset:64
    ds_read_b128 v[44:47], v8 offset:96
    ds_read_b128 v[48:51], v8 offset:256
    ds_read_b128 v[52:55], v8 offset:288
    ds_read_b128 v[56:59], v8 offset:320
    ds_read_b128 v[60:63], v8 offset:352
    v_add_u32 v2, 49152, v4
    s_nop 0
    ds_read_b64_tr_b16 v[16:17], v2 offset:0
    ds_read_b64_tr_b16 v[18:19], v2 offset:512
    ds_read_b64_tr_b16 v[20:21], v2 offset:2048
    ds_read_b64_tr_b16 v[22:23], v2 offset:2560
    ds_read_b64_tr_b16 v[24:25], v2 offset:4096
    ds_read_b64_tr_b16 v[26:27], v2 offset:4608
    ds_read_b64_tr_b16 v[28:29], v2 offset:6144
    s_waitcnt lgkmcnt(14)
    ds_read_b64_tr_b16 v[30:31], v2 offset:6656
    v_add_u32 v3, 73728, v4
    s_setprio 2
    s_waitcnt lgkmcnt(4)
    v_mfma_f32_32x32x16_bf16 v[32:47], v[16:19], v[112:115], v[32:47]
    ds_read_b64_tr_b16 v[104:105], v2 offset:8192
    ds_read_b64_tr_b16 v[106:107], v2 offset:8704
    v_mfma_f32_32x32x16_bf16 v[32:47], v[20:23], v[116:119], v[32:47]
    ds_read_b64_tr_b16 v[16:17], v2 offset:10240
    ds_read_b64_tr_b16 v[18:19], v2 offset:10752
    s_waitcnt lgkmcnt(4)
    v_mfma_f32_32x32x16_bf16 v[32:47], v[24:27], v[120:123], v[32:47]
    ds_read_b64_tr_b16 v[20:21], v2 offset:12288
    ds_read_b64_tr_b16 v[22:23], v2 offset:12800
    v_mfma_f32_32x32x16_bf16 v[32:47], v[28:31], v[124:127], v[32:47]
    ds_read_b64_tr_b16 v[24:25], v2 offset:14336
    ds_read_b64_tr_b16 v[26:27], v2 offset:14848
    s_setprio 1
    s_waitcnt lgkmcnt(4)
    v_mfma_f32_32x32x16_bf16 v[32:47], v[104:107], v[128:131], v[32:47]
    ds_read_b64_tr_b16 v[28:29], v2 offset:16384
    ds_read_b64_tr_b16 v[30:31], v2 offset:16896
    v_mfma_f32_32x32x16_bf16 v[32:47], v[16:19], v[132:135], v[32:47]
    ds_read_b64_tr_b16 v[104:105], v2 offset:18432
    ds_read_b64_tr_b16 v[106:107], v2 offset:18944
    s_waitcnt lgkmcnt(4)
    v_mfma_f32_32x32x16_bf16 v[32:47], v[20:23], v[136:139], v[32:47]
    ds_read_b64_tr_b16 v[16:17], v2 offset:20480
    ds_read_b64_tr_b16 v[18:19], v2 offset:20992
    v_mfma_f32_32x32x16_bf16 v[32:47], v[24:27], v[140:143], v[32:47]
    ds_read_b64_tr_b16 v[20:21], v2 offset:22528
    ds_read_b64_tr_b16 v[22:23], v2 offset:23040
    s_setprio 0
    s_waitcnt lgkmcnt(4)
    v_mfma_f32_32x32x16_bf16 v[32:47], v[28:31], v[144:147], v[32:47]
    ds_read_b64_tr_b16 v[24:25], v3 offset:0
    ds_read_b64_tr_b16 v[26:27], v3 offset:512
    v_mfma_f32_32x32x16_bf16 v[32:47], v[104:107], v[148:151], v[32:47]
    ds_read_b64_tr_b16 v[28:29], v3 offset:2048
    ds_read_b64_tr_b16 v[30:31], v3 offset:2560
    s_waitcnt lgkmcnt(4)
    v_mfma_f32_32x32x16_bf16 v[32:47], v[16:19], v[152:155], v[32:47]
    ds_read_b64_tr_b16 v[104:105], v3 offset:4096
    ds_read_b64_tr_b16 v[106:107], v3 offset:4608
    v_mfma_f32_32x32x16_bf16 v[32:47], v[20:23], v[156:159], v[32:47]
    ds_read_b64_tr_b16 v[16:17], v3 offset:6144
    ds_read_b64_tr_b16 v[18:19], v3 offset:6656
    s_waitcnt vmcnt(6)
    s_barrier
    v_add_u32 v2, 49152, v4
    v_xor_b32 v13, 0, v10
    v_add_u32 v13, 98304, v13
    v_xor_b32 v14, 32, v10
    v_add_u32 v14, 98304, v14
    v_xor_b32 v15, 64, v10
    v_add_u32 v15, 98304, v15
    v_xor_b32 v0, 96, v10
    v_add_u32 v0, 98304, v0
    ds_read_b128 v[160:163], v13 offset:0
    ds_read_b128 v[164:167], v14 offset:0
    ds_read_b128 v[168:171], v15 offset:0
    ds_read_b128 v[172:175], v0 offset:0
    ds_read_b128 v[176:179], v13 offset:16384
    ds_read_b128 v[180:183], v14 offset:16384
    ds_read_b128 v[184:187], v15 offset:16384
    s_waitcnt lgkmcnt(14)
    ds_read_b128 v[188:191], v0 offset:16384
    s_waitcnt lgkmcnt(14)
    ds_read_b128 v[192:195], v13 offset:32768
    s_waitcnt lgkmcnt(14)
    ds_read_b128 v[196:199], v14 offset:32768
    s_waitcnt lgkmcnt(14)
    ds_read_b128 v[200:203], v15 offset:32768
    s_waitcnt lgkmcnt(14)
    ds_read_b128 v[204:207], v0 offset:32768
    s_setprio 2
    s_waitcnt lgkmcnt(11)
    v_mfma_f32_32x32x16_bf16 v[32:47], v[24:27], v[160:163], v[32:47]
    ds_read_b64_tr_b16 v[20:21], v3 offset:8192
    ds_read_b64_tr_b16 v[22:23], v3 offset:8704
    s_add_u32 m0, s65, 49152
    s_add_u32 s36, s44, 3538944
    buffer_load_dwordx4 v6, s[8:11], s36 offen  lds
    s_waitcnt lgkmcnt(12)
    v_mfma_f32_32x32x16_bf16 v[32:47], v[28:31], v[164:167], v[32:47]
    ds_read_b64_tr_b16 v[24:25], v3 offset:10240
    ds_read_b64_tr_b16 v[26:27], v3 offset:10752
    s_add_u32 m0, s65, 50176
    s_add_u32 s36, s44, 3612672
    buffer_load_dwordx4 v6, s[8:11], s36 offen  lds
    s_waitcnt lgkmcnt(13)
    v_mfma_f32_32x32x16_bf16 v[32:47], v[104:107], v[168:171], v[32:47]
    ds_read_b64_tr_b16 v[28:29], v3 offset:12288
    ds_read_b64_tr_b16 v[30:31], v3 offset:12800
    s_add_u32 m0, s65, 51200
    s_add_u32 s36, s44, 3686400
    buffer_load_dwordx4 v6, s[8:11], s36 offen  lds
    s_waitcnt lgkmcnt(14)
    v_mfma_f32_32x32x16_bf16 v[32:47], v[16:19], v[172:175], v[32:47]
    ds_read_b64_tr_b16 v[104:105], v3 offset:14336
    s_waitcnt lgkmcnt(14)
    ds_read_b64_tr_b16 v[106:107], v3 offset:14848
    s_waitcnt lgkmcnt(8)
    s_barrier
    s_add_u32 m0, s65, 98304
    s_add_u32 s36, s45, 0
    buffer_load_dwordx4 v6, s[8:11], s36 offen  lds
    s_add_u32 m0, s65, 99328
    s_add_u32 s36, s45, 73728
    buffer_load_dwordx4 v6, s[8:11], s36 offen  lds
    s_setprio 1
    s_waitcnt lgkmcnt(4)
    v_mfma_f32_32x32x16_bf16 v[32:47], v[20:23], v[176:179], v[32:47]
    ds_read_b64_tr_b16 v[16:17], v3 offset:16384
    ds_read_b64_tr_b16 v[18:19], v3 offset:16896
    s_add_u32 m0, s65, 100352
    s_add_u32 s36, s45, 147456
    buffer_load_dwordx4 v6, s[8:11], s36 offen  lds
    s_add_u32 m0, s65, 122880
    s_add_u32 s36, s45, 1769472
    buffer_load_dwordx4 v6, s[8:11], s36 offen  lds
    v_mfma_f32_32x32x16_bf16 v[32:47], v[24:27], v[180:183], v[32:47]
    ds_read_b64_tr_b16 v[20:21], v3 offset:18432
    ds_read_b64_tr_b16 v[22:23], v3 offset:18944
    s_add_u32 m0, s65, 123904
    s_add_u32 s36, s45, 1843200
    buffer_load_dwordx4 v6, s[8:11], s36 offen  lds
    s_waitcnt lgkmcnt(4)
    v_mfma_f32_32x32x16_bf16 v[32:47], v[28:31], v[184:187], v[32:47]
    ds_read_b64_tr_b16 v[24:25], v3 offset:20480
    ds_read_b64_tr_b16 v[26:27], v3 offset:20992
    s_add_u32 m0, s65, 124928
    s_add_u32 s36, s45, 1916928
    buffer_load_dwordx4 v6, s[8:11], s36 offen  lds
    v_mfma_f32_32x32x16_bf16 v[32:47], v[104:107], v[188:191], v[32:47]
    ds_read_b64_tr_b16 v[28:29], v3 offset:22528
    ds_read_b64_tr_b16 v[30:31], v3 offset:23040
    s_setprio 0
    s_waitcnt lgkmcnt(4)
    v_mfma_f32_32x32x16_bf16 v[32:47], v[16:19], v[192:195], v[32:47]
    v_mfma_f32_32x32x16_bf16 v[32:47], v[20:23], v[196:199], v[32:47]
    s_waitcnt lgkmcnt(0)
    v_mfma_f32_32x32x16_bf16 v[32:47], v[24:27], v[200:203], v[32:47]
    v_mfma_f32_32x32x16_bf16 v[32:47], v[28:31], v[204:207], v[32:47]
    s_waitcnt vmcnt(6)
    s_barrier
    ds_read_b64_tr_b16 v[104:105], v2 offset:0
    ds_read_b64_tr_b16 v[106:107], v2 offset:512
    ds_read_b64_tr_b16 v[16:17], v2 offset:2048
    ds_read_b64_tr_b16 v[18:19], v2 offset:2560
    ds_read_b64_tr_b16 v[20:21], v2 offset:4096
    ds_read_b64_tr_b16 v[22:23], v2 offset:4608
    ds_read_b64_tr_b16 v[24:25], v2 offset:6144
    ds_read_b64_tr_b16 v[26:27], v2 offset:6656
    v_add_u32 v3, 98304, v4
    v_xor_b32 v13, 0, v10
    v_xor_b32 v14, 32, v10
    v_xor_b32 v15, 64, v10
    v_xor_b32 v0, 96, v10
    ds_read_b128 v[208:211], v13 offset:0
    ds_read_b128 v[212:215], v14 offset:0
    ds_read_b128 v[216:219], v15 offset:0
    ds_read_b128 v[220:223], v0 offset:0
    ds_read_b128 v[224:227], v13 offset:16384
    ds_read_b128 v[228:231], v14 offset:16384
    ds_read_b128 v[232:235], v15 offset:16384
    s_waitcnt lgkmcnt(14)
    ds_read_b128 v[236:239], v0 offset:16384
    s_waitcnt lgkmcnt(14)
    ds_read_b128 v[240:243], v13 offset:32768
    s_waitcnt lgkmcnt(14)
    ds_read_b128 v[244:247], v14 offset:32768
    s_waitcnt lgkmcnt(14)
    ds_read_b128 v[248:251], v15 offset:32768
    s_waitcnt lgkmcnt(14)
    ds_read_b128 v[252:255], v0 offset:32768
    s_setprio 2
    s_waitcnt lgkmcnt(11)
    v_mfma_f32_32x32x16_bf16 v[32:47], v[104:107], v[208:211], v[32:47]
    ds_read_b64_tr_b16 v[28:29], v2 offset:8192
    ds_read_b64_tr_b16 v[30:31], v2 offset:8704
    s_add_u32 m0, s65, 73728
    s_add_u32 s36, s45, 3538944
    buffer_load_dwordx4 v6, s[8:11], s36 offen  lds
    s_waitcnt lgkmcnt(12)
    v_mfma_f32_32x32x16_bf16 v[32:47], v[16:19], v[212:215], v[32:47]
    ds_read_b64_tr_b16 v[104:105], v2 offset:10240
    ds_read_b64_tr_b16 v[106:107], v2 offset:10752
    s_add_u32 m0, s65, 74752
    s_add_u32 s36, s45, 3612672
    buffer_load_dwordx4 v6, s[8:11], s36 offen  lds
    s_waitcnt lgkmcnt(13)
    v_mfma_f32_32x32x16_bf16 v[32:47], v[20:23], v[216:219], v[32:47]
    ds_read_b64_tr_b16 v[16:17], v2 offset:12288
    ds_read_b64_tr_b16 v[18:19], v2 offset:12800
    s_add_u32 m0, s65, 75776
    s_add_u32 s36, s45, 3686400
    buffer_load_dwordx4 v6, s[8:11], s36 offen  lds
    s_waitcnt lgkmcnt(14)
    v_mfma_f32_32x32x16_bf16 v[32:47], v[24:27], v[220:223], v[32:47]
    ds_read_b64_tr_b16 v[20:21], v2 offset:14336
    s_waitcnt lgkmcnt(14)
    ds_read_b64_tr_b16 v[22:23], v2 offset:14848
    s_setprio 1
    s_waitcnt lgkmcnt(4)
    v_mfma_f32_32x32x16_bf16 v[32:47], v[28:31], v[224:227], v[32:47]
    ds_read_b64_tr_b16 v[24:25], v2 offset:16384
    ds_read_b64_tr_b16 v[26:27], v2 offset:16896
    v_mfma_f32_32x32x16_bf16 v[32:47], v[104:107], v[228:231], v[32:47]
    ds_read_b64_tr_b16 v[28:29], v2 offset:18432
    ds_read_b64_tr_b16 v[30:31], v2 offset:18944
    s_waitcnt lgkmcnt(4)
    v_mfma_f32_32x32x16_bf16 v[32:47], v[16:19], v[232:235], v[32:47]
    ds_read_b64_tr_b16 v[104:105], v2 offset:20480
    ds_read_b64_tr_b16 v[106:107], v2 offset:20992
    v_mfma_f32_32x32x16_bf16 v[32:47], v[20:23], v[236:239], v[32:47]
    ds_read_b64_tr_b16 v[16:17], v2 offset:22528
    ds_read_b64_tr_b16 v[18:19], v2 offset:23040
    s_setprio 0
    s_waitcnt lgkmcnt(4)
    v_mfma_f32_32x32x16_bf16 v[32:47], v[24:27], v[240:243], v[32:47]
    v_mfma_f32_32x32x16_bf16 v[32:47], v[28:31], v[244:247], v[32:47]
    s_waitcnt lgkmcnt(0)
    v_mfma_f32_32x32x16_bf16 v[32:47], v[104:107], v[248:251], v[32:47]
    v_mfma_f32_32x32x16_bf16 v[32:47], v[16:19], v[252:255], v[32:47]
    s_waitcnt vmcnt(3)
    s_barrier
    ds_read_b64_tr_b16 v[20:21], v3 offset:0
    ds_read_b64_tr_b16 v[22:23], v3 offset:512
    ds_read_b64_tr_b16 v[24:25], v3 offset:2048
    ds_read_b64_tr_b16 v[26:27], v3 offset:2560
    ds_read_b64_tr_b16 v[28:29], v3 offset:4096
    ds_read_b64_tr_b16 v[30:31], v3 offset:4608
    ds_read_b64_tr_b16 v[104:105], v3 offset:6144
    ds_read_b64_tr_b16 v[106:107], v3 offset:6656
    v_add_u32 v2, 122880, v4
    s_setprio 2
    s_waitcnt lgkmcnt(4)
    v_mfma_f32_32x32x16_bf16 v[48:63], v[20:23], v[112:115], v[48:63]
    ds_read_b64_tr_b16 v[16:17], v3 offset:8192
    ds_read_b64_tr_b16 v[18:19], v3 offset:8704
    s_add_u32 m0, s65, 0
    s_add_u32 s36, s46, 0
    buffer_load_dwordx4 v6, s[8:11], s36 offen  lds
    s_add_u32 m0, s65, 1024
    s_add_u32 s36, s46, 73728
    buffer_load_dwordx4 v6, s[8:11], s36 offen  lds
    v_mfma_f32_32x32x16_bf16 v[48:63], v[24:27], v[116:119], v[48:63]
    ds_read_b64_tr_b16 v[20:21], v3 offset:10240
    ds_read_b64_tr_b16 v[22:23], v3 offset:10752
    s_add_u32 m0, s65, 2048
    s_add_u32 s36, s46, 147456
    buffer_load_dwordx4 v6, s[8:11], s36 offen  lds
    s_add_u32 m0, s65, 24576
    s_add_u32 s36, s46, 1769472
    buffer_load_dwordx4 v6, s[8:11], s36 offen  lds
    s_waitcnt lgkmcnt(4)
    v_mfma_f32_32x32x16_bf16 v[48:63], v[28:31], v[120:123], v[48:63]
    ds_read_b64_tr_b16 v[24:25], v3 offset:12288
    ds_read_b64_tr_b16 v[26:27], v3 offset:12800
    s_add_u32 m0, s65, 25600
    s_add_u32 s36, s46, 1843200
    buffer_load_dwordx4 v6, s[8:11], s36 offen  lds
    v_mul_f32_e32 v13, v32, v32
    v_mul_f32_e32 v14, v33, v33
    v_fma_f32 v13, v13, s37, v9
    v_mfma_f32_32x32x16_bf16 v[48:63], v[104:107], v[124:127], v[48:63]
    ds_read_b64_tr_b16 v[28:29], v3 offset:14336
    ds_read_b64_tr_b16 v[30:31], v3 offset:14848
    s_add_u32 m0, s65, 26624
    s_add_u32 s36, s46, 1916928
    buffer_load_dwordx4 v6, s[8:11], s36 offen  lds
    v_fma_f32 v14, v14, s37, v9
    v_mul_f32_e32 v13, v13, v32
    v_mul_f32_e32 v14, v14, v33
    v_exp_f32_e32 v13, v13
    s_setprio 1
    s_waitcnt lgkmcnt(4)
    v_mfma_f32_32x32x16_bf16 v[48:63], v[16:19], v[128:131], v[48:63]
    ds_read_b64_tr_b16 v[104:105], v3 offset:16384
    ds_read_b64_tr_b16 v[106:107], v3 offset:16896
    s_add_u32 m0, s65, 49152
    s_add_u32 s36, s46, 3538944
    buffer_load_dwordx4 v6, s[8:11], s36 offen  lds
    v_exp_f32_e32 v14, v14
    v_add_f32_e32 v13, 1.0, v13
    v_add_f32_e32 v14, 1.0, v14
    v_rcp_f32_e32 v13, v13
    v_mfma_f32_32x32x16_bf16 v[48:63], v[20:23], v[132:135], v[48:63]
    ds_read_b64_tr_b16 v[16:17], v3 offset:18432
    ds_read_b64_tr_b16 v[18:19], v3 offset:18944
    s_add_u32 m0, s65, 50176
    s_add_u32 s36, s46, 3612672
    buffer_load_dwordx4 v6, s[8:11], s36 offen  lds
    v_rcp_f32_e32 v14, v14
    v_mul_f32_e32 v13, v13, v32
    v_mul_f32_e32 v14, v14, v33
    v_cvt_pk_bf16_f32 v64, v13, v14
    s_waitcnt lgkmcnt(4)
    v_mfma_f32_32x32x16_bf16 v[48:63], v[24:27], v[136:139], v[48:63]
    ds_read_b64_tr_b16 v[20:21], v3 offset:20480
    ds_read_b64_tr_b16 v[22:23], v3 offset:20992
    s_add_u32 m0, s65, 51200
    s_add_u32 s36, s46, 3686400
    buffer_load_dwordx4 v6, s[8:11], s36 offen  lds
    v_mul_f32_e32 v15, v34, v34
    v_mul_f32_e32 v0, v35, v35
    v_fma_f32 v15, v15, s37, v9
    v_mfma_f32_32x32x16_bf16 v[48:63], v[28:31], v[140:143], v[48:63]
    ds_read_b64_tr_b16 v[24:25], v3 offset:22528
    ds_read_b64_tr_b16 v[26:27], v3 offset:23040
    v_fma_f32 v0, v0, s37, v9
    v_mul_f32_e32 v15, v15, v34
    v_mul_f32_e32 v0, v0, v35
    v_exp_f32_e32 v15, v15
    s_setprio 0
    s_waitcnt lgkmcnt(4)
    v_mfma_f32_32x32x16_bf16 v[48:63], v[104:107], v[144:147], v[48:63]
    ds_read_b64_tr_b16 v[28:29], v2 offset:0
    ds_read_b64_tr_b16 v[30:31], v2 offset:512
    v_exp_f32_e32 v0, v0
    v_add_f32_e32 v15, 1.0, v15
    v_add_f32_e32 v0, 1.0, v0
    v_rcp_f32_e32 v15, v15
    v_mfma_f32_32x32x16_bf16 v[48:63], v[16:19], v[148:151], v[48:63]
    ds_read_b64_tr_b16 v[104:105], v2 offset:2048
    ds_read_b64_tr_b16 v[106:107], v2 offset:2560
    v_rcp_f32_e32 v0, v0
    v_mul_f32_e32 v15, v15, v34
    v_mul_f32_e32 v0, v0, v35
    v_cvt_pk_bf16_f32 v65, v15, v0
    s_waitcnt lgkmcnt(4)
    v_mfma_f32_32x32x16_bf16 v[48:63], v[20:23], v[152:155], v[48:63]
    ds_read_b64_tr_b16 v[16:17], v2 offset:4096
    ds_read_b64_tr_b16 v[18:19], v2 offset:4608
    ds_read_b128 v[32:35], v8 offset:512
    v_mul_f32_e32 v13, v36, v36
    v_mul_f32_e32 v14, v37, v37
    v_mfma_f32_32x32x16_bf16 v[48:63], v[24:27], v[156:159], v[48:63]
    ds_read_b64_tr_b16 v[20:21], v2 offset:6144
    ds_read_b64_tr_b16 v[22:23], v2 offset:6656
    v_fma_f32 v13, v13, s37, v9
    v_fma_f32 v14, v14, s37, v9
    v_mul_f32_e32 v13, v13, v36
    v_mul_f32_e32 v14, v14, v37
    s_waitcnt vmcnt(9)
    s_barrier
    v_add_u32 v3, 73728, v4
    s_setprio 2
    s_waitcnt lgkmcnt(5)
    v_mfma_f32_32x32x16_bf16 v[48:63], v[28:31], v[160:163], v[48:63]
    ds_read_b64_tr_b16 v[24:25], v2 offset:8192
    ds_read_b64_tr_b16 v[26:27], v2 offset:8704
    s_add_u32 m0, s65, 98304
    s_add_u32 s36, s47, 0
    buffer_load_dwordx4 v6, s[8:11], s36 offen  lds
    v_exp_f32_e32 v13, v13
    v_exp_f32_e32 v14, v14
    v_add_f32_e32 v13, 1.0, v13
    v_add_f32_e32 v14, 1.0, v14
    v_mfma_f32_32x32x16_bf16 v[48:63], v[104:107], v[164:167], v[48:63]
    ds_read_b64_tr_b16 v[28:29], v2 offset:10240
    ds_read_b64_tr_b16 v[30:31], v2 offset:10752
    s_add_u32 m0, s65, 99328
    s_add_u32 s36, s47, 73728
    buffer_load_dwordx4 v6, s[8:11], s36 offen  lds
    v_rcp_f32_e32 v13, v13
    v_rcp_f32_e32 v14, v14
    v_mul_f32_e32 v13, v13, v36
    v_mul_f32_e32 v14, v14, v37
    s_waitcnt lgkmcnt(4)
    v_mfma_f32_32x32x16_bf16 v[48:63], v[16:19], v[168:171], v[48:63]
    ds_read_b64_tr_b16 v[104:105], v2 offset:12288
    ds_read_b64_tr_b16 v[106:107], v2 offset:12800
    s_add_u32 m0, s65, 100352
    s_add_u32 s36, s47, 147456
    buffer_load_dwordx4 v6, s[8:11], s36 offen  lds
    v_cvt_pk_bf16_f32 v66, v13, v14
    v_mul_f32_e32 v15, v38, v38
    v_mul_f32_e32 v0, v39, v39
    v_mfma_f32_32x32x16_bf16 v[48:63], v[20:23], v[172:175], v[48:63]
    ds_read_b64_tr_b16 v[16:17], v2 offset:14336
    ds_read_b64_tr_b16 v[18:19], v2 offset:14848
    v_fma_f32 v15, v15, s37, v9
    v_fma_f32 v0, v0, s37, v9
    v_mul_f32_e32 v15, v15, v38
    v_mul_f32_e32 v0, v0, v39
    s_setprio 1
    s_waitcnt lgkmcnt(4)
    v_mfma_f32_32x32x16_bf16 v[48:63], v[24:27], v[176:179], v[48:63]
    ds_read_b64_tr_b16 v[20:21], v2 offset:16384
    ds_read_b64_tr_b16 v[22:23], v2 offset:16896
    v_exp_f32_e32 v15, v15
    v_exp_f32_e32 v0, v0
    v_add_f32_e32 v15, 1.0, v15
    v_add_f32_e32 v0, 1.0, v0
    v_mfma_f32_32x32x16_bf16 v[48:63], v[28:31], v[180:183], v[48:63]
    ds_read_b64_tr_b16 v[24:25], v2 offset:18432
    ds_read_b64_tr_b16 v[26:27], v2 offset:18944
    v_rcp_f32_e32 v15, v15
    v_rcp_f32_e32 v0, v0
    v_mul_f32_e32 v15, v15, v38
    v_mul_f32_e32 v0, v0, v39
    s_waitcnt lgkmcnt(4)
    v_mfma_f32_32x32x16_bf16 v[48:63], v[104:107], v[184:187], v[48:63]
    ds_read_b64_tr_b16 v[28:29], v2 offset:20480
    ds_read_b64_tr_b16 v[30:31], v2 offset:20992
    v_cvt_pk_bf16_f32 v67, v15, v0
    ds_read_b128 v[36:39], v8 offset:544
    v_mul_f32_e32 v13, v40, v40
    v_mfma_f32_32x32x16_bf16 v[48:63], v[16:19], v[188:191], v[48:63]
    ds_read_b64_tr_b16 v[104:105], v2 offset:22528
    ds_read_b64_tr_b16 v[106:107], v2 offset:23040
    v_mul_f32_e32 v14, v41, v41
    v_fma_f32 v13, v13, s37, v9
    v_fma_f32 v14, v14, s37, v9
    v_mul_f32_e32 v13, v13, v40
    s_setprio 0
    s_waitcnt lgkmcnt(5)
    v_mfma_f32_32x32x16_bf16 v[48:63], v[20:23], v[192:195], v[48:63]
    ds_read_b64_tr_b16 v[16:17], v3 offset:0
    ds_read_b64_tr_b16 v[18:19], v3 offset:512
    v_mul_f32_e32 v14, v14, v41
    v_exp_f32_e32 v13, v13
    v_exp_f32_e32 v14, v14
    v_add_f32_e32 v13, 1.0, v13
    v_mfma_f32_32x32x16_bf16 v[48:63], v[24:27], v[196:199], v[48:63]
    ds_read_b64_tr_b16 v[20:21], v3 offset:2048
    ds_read_b64_tr_b16 v[22:23], v3 offset:2560
    v_add_f32_e32 v14, 1.0, v14
    v_rcp_f32_e32 v13, v13
    v_rcp_f32_e32 v14, v14
    v_mul_f32_e32 v13, v13, v40
    s_waitcnt lgkmcnt(4)
    v_mfma_f32_32x32x16_bf16 v[48:63], v[28:31], v[200:203], v[48:63]
    ds_read_b64_tr_b16 v[24:25], v3 offset:4096
    ds_read_b64_tr_b16 v[26:27], v3 offset:4608
    v_mul_f32_e32 v14, v14, v41
    v_cvt_pk_bf16_f32 v68, v13, v14
    v_mul_f32_e32 v15, v42, v42
    v_mfma_f32_32x32x16_bf16 v[48:63], v[104:107], v[204:207], v[48:63]
    ds_read_b64_tr_b16 v[28:29], v3 offset:6144
    ds_read_b64_tr_b16 v[30:31], v3 offset:6656
    v_mul_f32_e32 v0, v43, v43
    v_fma_f32 v15, v15, s37, v9
    v_fma_f32 v0, v0, s37, v9
    v_mul_f32_e32 v15, v15, v42
    s_waitcnt vmcnt(9)
    s_barrier
    v_add_u32 v2, 0, v4
    s_setprio 2
    s_waitcnt lgkmcnt(4)
    v_mfma_f32_32x32x16_bf16 v[48:63], v[16:19], v[208:211], v[48:63]
    ds_read_b64_tr_b16 v[104:105], v3 offset:8192
    ds_read_b64_tr_b16 v[106:107], v3 offset:8704
    s_add_u32 m0, s65, 122880
    s_add_u32 s36, s47, 1769472
    buffer_load_dwordx4 v6, s[8:11], s36 offen  lds
    v_mul_f32_e32 v0, v0, v43
    v_exp_f32_e32 v15, v15
    v_exp_f32_e32 v0, v0
    v_add_f32_e32 v15, 1.0, v15
    v_mfma_f32_32x32x16_bf16 v[48:63], v[20:23], v[212:215], v[48:63]
    ds_read_b64_tr_b16 v[16:17], v3 offset:10240
    ds_read_b64_tr_b16 v[18:19], v3 offset:10752
    s_add_u32 m0, s65, 123904
    s_add_u32 s36, s47, 1843200
    buffer_load_dwordx4 v6, s[8:11], s36 offen  lds
    v_add_f32_e32 v0, 1.0, v0
    v_rcp_f32_e32 v15, v15
    v_rcp_f32_e32 v0, v0
    v_mul_f32_e32 v15, v15, v42
    s_waitcnt lgkmcnt(4)
    v_mfma_f32_32x32x16_bf16 v[48:63], v[24:27], v[216:219], v[48:63]
    ds_read_b64_tr_b16 v[20:21], v3 offset:12288
    ds_read_b64_tr_b16 v[22:23], v3 offset:12800
    s_add_u32 m0, s65, 124928
    s_add_u32 s36, s47, 1916928
    buffer_load_dwordx4 v6, s[8:11], s36 offen  lds
    v_mul_f32_e32 v0, v0, v43
    v_cvt_pk_bf16_f32 v69, v15, v0
    ds_read_b128 v[40:43], v8 offset:576
    v_mfma_f32_32x32x16_bf16 v[48:63], v[28:31], v[220:223], v[48:63]
    ds_read_b64_tr_b16 v[24:25], v3 offset:14336
    ds_read_b64_tr_b16 v[26:27], v3 offset:14848
    v_mul_f32_e32 v13, v44, v44
    v_mul_f32_e32 v14, v45, v45
    v_fma_f32 v13, v13, s37, v9
    v_fma_f32 v14, v14, s37, v9
    s_setprio 1
    s_waitcnt lgkmcnt(5)
    v_mfma_f32_32x32x16_bf16 v[48:63], v[104:107], v[224:227], v[48:63]
    ds_read_b64_tr_b16 v[28:29], v3 offset:16384
    ds_read_b64_tr_b16 v[30:31], v3 offset:16896
    v_mul_f32_e32 v13, v13, v44
    v_mul_f32_e32 v14, v14, v45
    v_exp_f32_e32 v13, v13
    v_exp_f32_e32 v14, v14
    v_mfma_f32_32x32x16_bf16 v[48:63], v[16:19], v[228:231], v[48:63]
    ds_read_b64_tr_b16 v[104:105], v3 offset:18432
    ds_read_b64_tr_b16 v[106:107], v3 offset:18944
    v_add_f32_e32 v13, 1.0, v13
    v_add_f32_e32 v14, 1.0, v14
    v_rcp_f32_e32 v13, v13
    v_rcp_f32_e32 v14, v14
    s_waitcnt lgkmcnt(4)
    v_mfma_f32_32x32x16_bf16 v[48:63], v[20:23], v[232:235], v[48:63]
    ds_read_b64_tr_b16 v[16:17], v3 offset:20480
    ds_read_b64_tr_b16 v[18:19], v3 offset:20992
    v_mul_f32_e32 v13, v13, v44
    v_mul_f32_e32 v14, v14, v45
    v_cvt_pk_bf16_f32 v70, v13, v14
    v_mfma_f32_32x32x16_bf16 v[48:63], v[24:27], v[236:239], v[48:63]
    ds_read_b64_tr_b16 v[20:21], v3 offset:22528
    ds_read_b64_tr_b16 v[22:23], v3 offset:23040
    v_mul_f32_e32 v15, v46, v46
    v_mul_f32_e32 v0, v47, v47
    v_fma_f32 v15, v15, s37, v9
    v_fma_f32 v0, v0, s37, v9
    s_setprio 0
    s_waitcnt lgkmcnt(4)
    v_mfma_f32_32x32x16_bf16 v[48:63], v[28:31], v[240:243], v[48:63]
    ds_read_b64_tr_b16 v[24:25], v2 offset:0
    ds_read_b64_tr_b16 v[26:27], v2 offset:512
    v_mul_f32_e32 v15, v15, v46
    v_mul_f32_e32 v0, v0, v47
    v_exp_f32_e32 v15, v15
    v_exp_f32_e32 v0, v0
    v_mfma_f32_32x32x16_bf16 v[48:63], v[104:107], v[244:247], v[48:63]
    ds_read_b64_tr_b16 v[28:29], v2 offset:2048
    ds_read_b64_tr_b16 v[30:31], v2 offset:2560
    v_add_f32_e32 v15, 1.0, v15
    v_add_f32_e32 v0, 1.0, v0
    v_rcp_f32_e32 v15, v15
    v_rcp_f32_e32 v0, v0
    s_waitcnt lgkmcnt(4)
    v_mfma_f32_32x32x16_bf16 v[48:63], v[16:19], v[248:251], v[48:63]
    ds_read_b64_tr_b16 v[104:105], v2 offset:4096
    ds_read_b64_tr_b16 v[106:107], v2 offset:4608
    v_mul_f32_e32 v15, v15, v46
    v_mul_f32_e32 v0, v0, v47
    v_cvt_pk_bf16_f32 v71, v15, v0
    ds_read_b128 v[44:47], v8 offset:608
    v_mfma_f32_32x32x16_bf16 v[48:63], v[20:23], v[252:255], v[48:63]
    ds_read_b64_tr_b16 v[16:17], v2 offset:6144
    ds_read_b64_tr_b16 v[18:19], v2 offset:6656
    s_waitcnt vmcnt(9)
    s_barrier
    v_add_u32 v3, 24576, v4
    s_setprio 2
    s_waitcnt lgkmcnt(5)
    s_waitcnt lgkmcnt(2)
    v_mfma_f32_32x32x16_bf16 v[32:47], v[24:27], v[112:115], v[32:47]
    ds_read_b64_tr_b16 v[20:21], v2 offset:8192
    ds_read_b64_tr_b16 v[22:23], v2 offset:8704
    s_add_u32 m0, s65, 73728
    s_add_u32 s36, s47, 3538944
    buffer_load_dwordx4 v6, s[8:11], s36 offen  lds
    v_mfma_f32_32x32x16_bf16 v[32:47], v[28:31], v[116:119], v[32:47]
    ds_read_b64_tr_b16 v[24:25], v2 offset:10240
    ds_read_b64_tr_b16 v[26:27], v2 offset:10752
    s_add_u32 m0, s65, 74752
    s_add_u32 s36, s47, 3612672
    buffer_load_dwordx4 v6, s[8:11], s36 offen  lds
    s_waitcnt lgkmcnt(4)
    v_mfma_f32_32x32x16_bf16 v[32:47], v[104:107], v[120:123], v[32:47]
    ds_read_b64_tr_b16 v[28:29], v2 offset:12288
    ds_read_b64_tr_b16 v[30:31], v2 offset:12800
    s_add_u32 m0, s65, 75776
    s_add_u32 s36, s47, 3686400
    buffer_load_dwordx4 v6, s[8:11], s36 offen  lds
    v_mul_f32_e32 v13, v48, v48
    v_mul_f32_e32 v14, v49, v49
    v_fma_f32 v13, v13, s37, v9
    v_mfma_f32_32x32x16_bf16 v[32:47], v[16:19], v[124:127], v[32:47]
    ds_read_b64_tr_b16 v[104:105], v2 offset:14336
    ds_read_b64_tr_b16 v[106:107], v2 offset:14848
    v_fma_f32 v14, v14, s37, v9
    v_mul_f32_e32 v13, v13, v48
    v_mul_f32_e32 v14, v14, v49
    v_exp_f32_e32 v13, v13
    s_setprio 1
    s_waitcnt lgkmcnt(4)
    v_mfma_f32_32x32x16_bf16 v[32:47], v[20:23], v[128:131], v[32:47]
    ds_read_b64_tr_b16 v[16:17], v2 offset:16384
    ds_read_b64_tr_b16 v[18:19], v2 offset:16896
    v_exp_f32_e32 v14, v14
    v_add_f32_e32 v13, 1.0, v13
    v_add_f32_e32 v14, 1.0, v14
    v_rcp_f32_e32 v13, v13
    v_mfma_f32_32x32x16_bf16 v[32:47], v[24:27], v[132:135], v[32:47]
    ds_read_b64_tr_b16 v[20:21], v2 offset:18432
    ds_read_b64_tr_b16 v[22:23], v2 offset:18944
    v_rcp_f32_e32 v14, v14
    v_mul_f32_e32 v13, v13, v48
    v_mul_f32_e32 v14, v14, v49
    v_cvt_pk_bf16_f32 v72, v13, v14
    s_waitcnt lgkmcnt(4)
    v_mfma_f32_32x32x16_bf16 v[32:47], v[28:31], v[136:139], v[32:47]
    ds_read_b64_tr_b16 v[24:25], v2 offset:20480
    ds_read_b64_tr_b16 v[26:27], v2 offset:20992
    v_mul_f32_e32 v15, v50, v50
    v_mul_f32_e32 v0, v51, v51
    v_fma_f32 v15, v15, s37, v9
    v_mfma_f32_32x32x16_bf16 v[32:47], v[104:107], v[140:143], v[32:47]
    ds_read_b64_tr_b16 v[28:29], v2 offset:22528
    ds_read_b64_tr_b16 v[30:31], v2 offset:23040
    v_fma_f32 v0, v0, s37, v9
    v_mul_f32_e32 v15, v15, v50
    v_mul_f32_e32 v0, v0, v51
    v_exp_f32_e32 v15, v15
    s_setprio 0
    s_waitcnt lgkmcnt(4)
    v_mfma_f32_32x32x16_bf16 v[32:47], v[16:19], v[144:147], v[32:47]
    ds_read_b64_tr_b16 v[104:105], v3 offset:0
    ds_read_b64_tr_b16 v[106:107], v3 offset:512
    v_exp_f32_e32 v0, v0
    v_add_f32_e32 v15, 1.0, v15
    v_add_f32_e32 v0, 1.0, v0
    v_rcp_f32_e32 v15, v15
    v_mfma_f32_32x32x16_bf16 v[32:47], v[20:23], v[148:151], v[32:47]
    ds_read_b64_tr_b16 v[16:17], v3 offset:2048
    ds_read_b64_tr_b16 v[18:19], v3 offset:2560
    v_rcp_f32_e32 v0, v0
    v_mul_f32_e32 v15, v15, v50
    v_mul_f32_e32 v0, v0, v51
    v_cvt_pk_bf16_f32 v73, v15, v0
    s_waitcnt lgkmcnt(4)
    v_mfma_f32_32x32x16_bf16 v[32:47], v[24:27], v[152:155], v[32:47]
    ds_read_b64_tr_b16 v[20:21], v3 offset:4096
    ds_read_b64_tr_b16 v[22:23], v3 offset:4608
    ds_read_b128 v[48:51], v8 offset:768
    v_mul_f32_e32 v13, v52, v52
    v_mul_f32_e32 v14, v53, v53
    v_mfma_f32_32x32x16_bf16 v[32:47], v[28:31], v[156:159], v[32:47]
    ds_read_b64_tr_b16 v[24:25], v3 offset:6144
    ds_read_b64_tr_b16 v[26:27], v3 offset:6656
    v_fma_f32 v13, v13, s37, v9
    v_fma_f32 v14, v14, s37, v9
    v_mul_f32_e32 v13, v13, v52
    v_mul_f32_e32 v14, v14, v53
    s_waitcnt vmcnt(9)
    s_barrier
    v_add_u32 v2, 49152, v4
    s_setprio 2
    s_waitcnt lgkmcnt(5)
    v_mfma_f32_32x32x16_bf16 v[32:47], v[104:107], v[160:163], v[32:47]
    ds_read_b64_tr_b16 v[28:29], v3 offset:8192
    ds_read_b64_tr_b16 v[30:31], v3 offset:8704
    s_add_u32 m0, s65, 0
    s_add_u32 s36, s48, 0
    buffer_load_dwordx4 v6, s[8:11], s36 offen  lds
    v_exp_f32_e32 v13, v13
    v_exp_f32_e32 v14, v14
    v_add_f32_e32 v13, 1.0, v13
    v_add_f32_e32 v14, 1.0, v14
    v_mfma_f32_32x32x16_bf16 v[32:47], v[16:19], v[164:167], v[32:47]
    ds_read_b64_tr_b16 v[104:105], v3 offset:10240
    ds_read_b64_tr_b16 v[106:107], v3 offset:10752
    s_add_u32 m0, s65, 1024
    s_add_u32 s36, s48, 73728
    buffer_load_dwordx4 v6, s[8:11], s36 offen  lds
    v_rcp_f32_e32 v13, v13
    v_rcp_f32_e32 v14, v14
    v_mul_f32_e32 v13, v13, v52
    v_mul_f32_e32 v14, v14, v53
    s_waitcnt lgkmcnt(4)
    v_mfma_f32_32x32x16_bf16 v[32:47], v[20:23], v[168:171], v[32:47]
    ds_read_b64_tr_b16 v[16:17], v3 offset:12288
    ds_read_b64_tr_b16 v[18:19], v3 offset:12800
    s_add_u32 m0, s65, 2048
    s_add_u32 s36, s48, 147456
    buffer_load_dwordx4 v6, s[8:11], s36 offen  lds
    v_cvt_pk_bf16_f32 v74, v13, v14
    v_mul_f32_e32 v15, v54, v54
    v_mul_f32_e32 v0, v55, v55
    v_mfma_f32_32x32x16_bf16 v[32:47], v[24:27], v[172:175], v[32:47]
    ds_read_b64_tr_b16 v[20:21], v3 offset:14336
    ds_read_b64_tr_b16 v[22:23], v3 offset:14848
    v_fma_f32 v15, v15, s37, v9
    v_fma_f32 v0, v0, s37, v9
    v_mul_f32_e32 v15, v15, v54
    v_mul_f32_e32 v0, v0, v55
    s_setprio 1
    s_waitcnt lgkmcnt(4)
    v_mfma_f32_32x32x16_bf16 v[32:47], v[28:31], v[176:179], v[32:47]
    ds_read_b64_tr_b16 v[24:25], v3 offset:16384
    ds_read_b64_tr_b16 v[26:27], v3 offset:16896
    v_exp_f32_e32 v15, v15
    v_exp_f32_e32 v0, v0
    v_add_f32_e32 v15, 1.0, v15
    v_add_f32_e32 v0, 1.0, v0
    v_mfma_f32_32x32x16_bf16 v[32:47], v[104:107], v[180:183], v[32:47]
    ds_read_b64_tr_b16 v[28:29], v3 offset:18432
    ds_read_b64_tr_b16 v[30:31], v3 offset:18944
    v_rcp_f32_e32 v15, v15
    v_rcp_f32_e32 v0, v0
    v_mul_f32_e32 v15, v15, v54
    v_mul_f32_e32 v0, v0, v55
    s_waitcnt lgkmcnt(4)
    v_mfma_f32_32x32x16_bf16 v[32:47], v[16:19], v[184:187], v[32:47]
    ds_read_b64_tr_b16 v[104:105], v3 offset:20480
    ds_read_b64_tr_b16 v[106:107], v3 offset:20992
    v_cvt_pk_bf16_f32 v75, v15, v0
    ds_read_b128 v[52:55], v8 offset:800
    v_mul_f32_e32 v13, v56, v56
    v_mfma_f32_32x32x16_bf16 v[32:47], v[20:23], v[188:191], v[32:47]
    ds_read_b64_tr_b16 v[16:17], v3 offset:22528
    ds_read_b64_tr_b16 v[18:19], v3 offset:23040
    v_mul_f32_e32 v14, v57, v57
    v_fma_f32 v13, v13, s37, v9
    v_fma_f32 v14, v14, s37, v9
    v_mul_f32_e32 v13, v13, v56
    s_setprio 0
    s_waitcnt lgkmcnt(5)
    v_mfma_f32_32x32x16_bf16 v[32:47], v[24:27], v[192:195], v[32:47]
    ds_read_b64_tr_b16 v[20:21], v2 offset:0
    ds_read_b64_tr_b16 v[22:23], v2 offset:512
    v_mul_f32_e32 v14, v14, v57
    v_exp_f32_e32 v13, v13
    v_exp_f32_e32 v14, v14
    v_add_f32_e32 v13, 1.0, v13
    v_mfma_f32_32x32x16_bf16 v[32:47], v[28:31], v[196:199], v[32:47]
    ds_read_b64_tr_b16 v[24:25], v2 offset:2048
    ds_read_b64_tr_b16 v[26:27], v2 offset:2560
    v_add_f32_e32 v14, 1.0, v14
    v_rcp_f32_e32 v13, v13
    v_rcp_f32_e32 v14, v14
    v_mul_f32_e32 v13, v13, v56
    s_waitcnt lgkmcnt(4)
    v_mfma_f32_32x32x16_bf16 v[32:47], v[104:107], v[200:203], v[32:47]
    ds_read_b64_tr_b16 v[28:29], v2 offset:4096
    ds_read_b64_tr_b16 v[30:31], v2 offset:4608
    v_mul_f32_e32 v14, v14, v57
    v_cvt_pk_bf16_f32 v76, v13, v14
    v_mul_f32_e32 v15, v58, v58
    v_mfma_f32_32x32x16_bf16 v[32:47], v[16:19], v[204:207], v[32:47]
    ds_read_b64_tr_b16 v[104:105], v2 offset:6144
    ds_read_b64_tr_b16 v[106:107], v2 offset:6656
    v_mul_f32_e32 v0, v59, v59
    v_fma_f32 v15, v15, s37, v9
    v_fma_f32 v0, v0, s37, v9
    v_mul_f32_e32 v15, v15, v58
    s_waitcnt vmcnt(9)
    s_barrier
    v_add_u32 v3, 98304, v4
    s_setprio 2
    s_waitcnt lgkmcnt(4)
    v_mfma_f32_32x32x16_bf16 v[32:47], v[20:23], v[208:211], v[32:47]
    ds_read_b64_tr_b16 v[16:17], v2 offset:8192
    ds_read_b64_tr_b16 v[18:19], v2 offset:8704
    s_add_u32 m0, s65, 24576
    s_add_u32 s36, s48, 1769472
    buffer_load_dwordx4 v6, s[8:11], s36 offen  lds
    v_mul_f32_e32 v0, v0, v59
    v_exp_f32_e32 v15, v15
    v_exp_f32_e32 v0, v0
    v_add_f32_e32 v15, 1.0, v15
    v_mfma_f32_32x32x16_bf16 v[32:47], v[24:27], v[212:215], v[32:47]
    ds_read_b64_tr_b16 v[20:21], v2 offset:10240
    ds_read_b64_tr_b16 v[22:23], v2 offset:10752
    s_add_u32 m0, s65, 25600
    s_add_u32 s36, s48, 1843200
    buffer_load_dwordx4 v6, s[8:11], s36 offen  lds
    v_add_f32_e32 v0, 1.0, v0
    v_rcp_f32_e32 v15, v15
    v_rcp_f32_e32 v0, v0
    v_mul_f32_e32 v15, v15, v58
    s_waitcnt lgkmcnt(4)
    v_mfma_f32_32x32x16_bf16 v[32:47], v[28:31], v[216:219], v[32:47]
    ds_read_b64_tr_b16 v[24:25], v2 offset:12288
    ds_read_b64_tr_b16 v[26:27], v2 offset:12800
    s_add_u32 m0, s65, 26624
    s_add_u32 s36, s48, 1916928
    buffer_load_dwordx4 v6, s[8:11], s36 offen  lds
    v_mul_f32_e32 v0, v0, v59
    v_cvt_pk_bf16_f32 v77, v15, v0
    ds_read_b128 v[56:59], v8 offset:832
    v_mfma_f32_32x32x16_bf16 v[32:47], v[104:107], v[220:223], v[32:47]
    ds_read_b64_tr_b16 v[28:29], v2 offset:14336
    ds_read_b64_tr_b16 v[30:31], v2 offset:14848
    v_mul_f32_e32 v13, v60, v60
    v_mul_f32_e32 v14, v61, v61
    v_fma_f32 v13, v13, s37, v9
    v_fma_f32 v14, v14, s37, v9
    s_setprio 1
    s_waitcnt lgkmcnt(5)
    v_mfma_f32_32x32x16_bf16 v[32:47], v[16:19], v[224:227], v[32:47]
    ds_read_b64_tr_b16 v[104:105], v2 offset:16384
    ds_read_b64_tr_b16 v[106:107], v2 offset:16896
    v_mul_f32_e32 v13, v13, v60
    v_mul_f32_e32 v14, v14, v61
    v_exp_f32_e32 v13, v13
    v_exp_f32_e32 v14, v14
    v_mfma_f32_32x32x16_bf16 v[32:47], v[20:23], v[228:231], v[32:47]
    ds_read_b64_tr_b16 v[16:17], v2 offset:18432
    ds_read_b64_tr_b16 v[18:19], v2 offset:18944
    v_add_f32_e32 v13, 1.0, v13
    v_add_f32_e32 v14, 1.0, v14
    v_rcp_f32_e32 v13, v13
    v_rcp_f32_e32 v14, v14
    s_waitcnt lgkmcnt(4)
    v_mfma_f32_32x32x16_bf16 v[32:47], v[24:27], v[232:235], v[32:47]
    ds_read_b64_tr_b16 v[20:21], v2 offset:20480
    ds_read_b64_tr_b16 v[22:23], v2 offset:20992
    v_mul_f32_e32 v13, v13, v60
    v_mul_f32_e32 v14, v14, v61
    v_cvt_pk_bf16_f32 v78, v13, v14
    v_mfma_f32_32x32x16_bf16 v[32:47], v[28:31], v[236:239], v[32:47]
    ds_read_b64_tr_b16 v[24:25], v2 offset:22528
    ds_read_b64_tr_b16 v[26:27], v2 offset:23040
    v_mul_f32_e32 v15, v62, v62
    v_mul_f32_e32 v0, v63, v63
    v_fma_f32 v15, v15, s37, v9
    v_fma_f32 v0, v0, s37, v9
    s_setprio 0
    s_waitcnt lgkmcnt(4)
    v_mfma_f32_32x32x16_bf16 v[32:47], v[104:107], v[240:243], v[32:47]
    ds_read_b64_tr_b16 v[28:29], v3 offset:0
    ds_read_b64_tr_b16 v[30:31], v3 offset:512
    v_mul_f32_e32 v15, v15, v62
    v_mul_f32_e32 v0, v0, v63
    v_exp_f32_e32 v15, v15
    v_exp_f32_e32 v0, v0
    v_mfma_f32_32x32x16_bf16 v[32:47], v[16:19], v[244:247], v[32:47]
    ds_read_b64_tr_b16 v[104:105], v3 offset:2048
    ds_read_b64_tr_b16 v[106:107], v3 offset:2560
    v_add_f32_e32 v15, 1.0, v15
    v_add_f32_e32 v0, 1.0, v0
    v_rcp_f32_e32 v15, v15
    v_rcp_f32_e32 v0, v0
    s_waitcnt lgkmcnt(4)
    v_mfma_f32_32x32x16_bf16 v[32:47], v[20:23], v[248:251], v[32:47]
    ds_read_b64_tr_b16 v[16:17], v3 offset:4096
    ds_read_b64_tr_b16 v[18:19], v3 offset:4608
    v_mul_f32_e32 v15, v15, v62
    v_mul_f32_e32 v0, v0, v63
    v_cvt_pk_bf16_f32 v79, v15, v0
    ds_read_b128 v[60:63], v8 offset:864
    v_mfma_f32_32x32x16_bf16 v[32:47], v[24:27], v[252:255], v[32:47]
    ds_read_b64_tr_b16 v[20:21], v3 offset:6144
    ds_read_b64_tr_b16 v[22:23], v3 offset:6656
    s_waitcnt vmcnt(9)
    s_barrier
    v_add_u32 v2, 122880, v4
    s_setprio 2
    s_waitcnt lgkmcnt(5)
    s_waitcnt lgkmcnt(2)
    v_mfma_f32_32x32x16_bf16 v[48:63], v[28:31], v[112:115], v[48:63]
    ds_read_b64_tr_b16 v[24:25], v3 offset:8192
    ds_read_b64_tr_b16 v[26:27], v3 offset:8704
    s_add_u32 m0, s65, 49152
    s_add_u32 s36, s48, 3538944
    buffer_load_dwordx4 v6, s[8:11], s36 offen  lds
    v_mfma_f32_32x32x16_bf16 v[48:63], v[104:107], v[116:119], v[48:63]
    ds_read_b64_tr_b16 v[28:29], v3 offset:10240
    ds_read_b64_tr_b16 v[30:31], v3 offset:10752
    s_add_u32 m0, s65, 50176
    s_add_u32 s36, s48, 3612672
    buffer_load_dwordx4 v6, s[8:11], s36 offen  lds
    s_waitcnt lgkmcnt(4)
    v_mfma_f32_32x32x16_bf16 v[48:63], v[16:19], v[120:123], v[48:63]
    ds_read_b64_tr_b16 v[104:105], v3 offset:12288
    ds_read_b64_tr_b16 v[106:107], v3 offset:12800
    s_add_u32 m0, s65, 51200
    s_add_u32 s36, s48, 3686400
    buffer_load_dwordx4 v6, s[8:11], s36 offen  lds
    v_mul_f32_e32 v13, v32, v32
    v_mul_f32_e32 v14, v33, v33
    v_fma_f32 v13, v13, s37, v9
    v_mfma_f32_32x32x16_bf16 v[48:63], v[20:23], v[124:127], v[48:63]
    ds_read_b64_tr_b16 v[16:17], v3 offset:14336
    ds_read_b64_tr_b16 v[18:19], v3 offset:14848
    v_fma_f32 v14, v14, s37, v9
    v_mul_f32_e32 v13, v13, v32
    v_mul_f32_e32 v14, v14, v33
    v_exp_f32_e32 v13, v13
    s_setprio 1
    s_waitcnt lgkmcnt(4)
    v_mfma_f32_32x32x16_bf16 v[48:63], v[24:27], v[128:131], v[48:63]
    ds_read_b64_tr_b16 v[20:21], v3 offset:16384
    ds_read_b64_tr_b16 v[22:23], v3 offset:16896
    v_exp_f32_e32 v14, v14
    v_add_f32_e32 v13, 1.0, v13
    v_add_f32_e32 v14, 1.0, v14
    v_rcp_f32_e32 v13, v13
    v_mfma_f32_32x32x16_bf16 v[48:63], v[28:31], v[132:135], v[48:63]
    ds_read_b64_tr_b16 v[24:25], v3 offset:18432
    ds_read_b64_tr_b16 v[26:27], v3 offset:18944
    v_rcp_f32_e32 v14, v14
    v_mul_f32_e32 v13, v13, v32
    v_mul_f32_e32 v14, v14, v33
    v_cvt_pk_bf16_f32 v80, v13, v14
    s_waitcnt lgkmcnt(4)
    v_mfma_f32_32x32x16_bf16 v[48:63], v[104:107], v[136:139], v[48:63]
    ds_read_b64_tr_b16 v[28:29], v3 offset:20480
    ds_read_b64_tr_b16 v[30:31], v3 offset:20992
    v_mul_f32_e32 v15, v34, v34
    v_mul_f32_e32 v0, v35, v35
    v_fma_f32 v15, v15, s37, v9
    v_mfma_f32_32x32x16_bf16 v[48:63], v[16:19], v[140:143], v[48:63]
    ds_read_b64_tr_b16 v[104:105], v3 offset:22528
    ds_read_b64_tr_b16 v[106:107], v3 offset:23040
    v_fma_f32 v0, v0, s37, v9
    v_mul_f32_e32 v15, v15, v34
    v_mul_f32_e32 v0, v0, v35
    v_exp_f32_e32 v15, v15
    s_setprio 0
    s_waitcnt lgkmcnt(4)
    v_mfma_f32_32x32x16_bf16 v[48:63], v[20:23], v[144:147], v[48:63]
    ds_read_b64_tr_b16 v[16:17], v2 offset:0
    ds_read_b64_tr_b16 v[18:19], v2 offset:512
    v_exp_f32_e32 v0, v0
    v_add_f32_e32 v15, 1.0, v15
    v_add_f32_e32 v0, 1.0, v0
    v_rcp_f32_e32 v15, v15
    v_mfma_f32_32x32x16_bf16 v[48:63], v[24:27], v[148:151], v[48:63]
    ds_read_b64_tr_b16 v[20:21], v2 offset:2048
    ds_read_b64_tr_b16 v[22:23], v2 offset:2560
    v_rcp_f32_e32 v0, v0
    v_mul_f32_e32 v15, v15, v34
    v_mul_f32_e32 v0, v0, v35
    v_cvt_pk_bf16_f32 v81, v15, v0
    s_waitcnt lgkmcnt(4)
    v_mfma_f32_32x32x16_bf16 v[48:63], v[28:31], v[152:155], v[48:63]
    ds_read_b64_tr_b16 v[24:25], v2 offset:4096
    ds_read_b64_tr_b16 v[26:27], v2 offset:4608
    ds_read_b128 v[32:35], v8 offset:1024
    v_mul_f32_e32 v13, v36, v36
    v_mul_f32_e32 v14, v37, v37
    v_mfma_f32_32x32x16_bf16 v[48:63], v[104:107], v[156:159], v[48:63]
    ds_read_b64_tr_b16 v[28:29], v2 offset:6144
    ds_read_b64_tr_b16 v[30:31], v2 offset:6656
    v_fma_f32 v13, v13, s37, v9
    v_fma_f32 v14, v14, s37, v9
    v_mul_f32_e32 v13, v13, v36
    v_mul_f32_e32 v14, v14, v37
    s_waitcnt vmcnt(9)
    s_barrier
    v_add_u32 v3, 73728, v4
    s_setprio 2
    s_waitcnt lgkmcnt(5)
    v_mfma_f32_32x32x16_bf16 v[48:63], v[16:19], v[160:163], v[48:63]
    ds_read_b64_tr_b16 v[104:105], v2 offset:8192
    ds_read_b64_tr_b16 v[106:107], v2 offset:8704
    s_add_u32 m0, s65, 98304
    s_add_u32 s36, s49, 0
    buffer_load_dwordx4 v6, s[8:11], s36 offen  lds
    v_exp_f32_e32 v13, v13
    v_exp_f32_e32 v14, v14
    v_add_f32_e32 v13, 1.0, v13
    v_add_f32_e32 v14, 1.0, v14
    v_mfma_f32_32x32x16_bf16 v[48:63], v[20:23], v[164:167], v[48:63]
    ds_read_b64_tr_b16 v[16:17], v2 offset:10240
    ds_read_b64_tr_b16 v[18:19], v2 offset:10752
    s_add_u32 m0, s65, 99328
    s_add_u32 s36, s49, 73728
    buffer_load_dwordx4 v6, s[8:11], s36 offen  lds
    v_rcp_f32_e32 v13, v13
    v_rcp_f32_e32 v14, v14
    v_mul_f32_e32 v13, v13, v36
    v_mul_f32_e32 v14, v14, v37
    s_waitcnt lgkmcnt(4)
    v_mfma_f32_32x32x16_bf16 v[48:63], v[24:27], v[168:171], v[48:63]
    ds_read_b64_tr_b16 v[20:21], v2 offset:12288
    ds_read_b64_tr_b16 v[22:23], v2 offset:12800
    s_add_u32 m0, s65, 100352
    s_add_u32 s36, s49, 147456
    buffer_load_dwordx4 v6, s[8:11], s36 offen  lds
    v_cvt_pk_bf16_f32 v82, v13, v14
    v_mul_f32_e32 v15, v38, v38
    v_mul_f32_e32 v0, v39, v39
    v_mfma_f32_32x32x16_bf16 v[48:63], v[28:31], v[172:175], v[48:63]
    ds_read_b64_tr_b16 v[24:25], v2 offset:14336
    ds_read_b64_tr_b16 v[26:27], v2 offset:14848
    v_fma_f32 v15, v15, s37, v9
    v_fma_f32 v0, v0, s37, v9
    v_mul_f32_e32 v15, v15, v38
    v_mul_f32_e32 v0, v0, v39
    s_setprio 1
    s_waitcnt lgkmcnt(4)
    v_mfma_f32_32x32x16_bf16 v[48:63], v[104:107], v[176:179], v[48:63]
    ds_read_b64_tr_b16 v[28:29], v2 offset:16384
    ds_read_b64_tr_b16 v[30:31], v2 offset:16896
    v_exp_f32_e32 v15, v15
    v_exp_f32_e32 v0, v0
    v_add_f32_e32 v15, 1.0, v15
    v_add_f32_e32 v0, 1.0, v0
    v_mfma_f32_32x32x16_bf16 v[48:63], v[16:19], v[180:183], v[48:63]
    ds_read_b64_tr_b16 v[104:105], v2 offset:18432
    ds_read_b64_tr_b16 v[106:107], v2 offset:18944
    v_rcp_f32_e32 v15, v15
    v_rcp_f32_e32 v0, v0
    v_mul_f32_e32 v15, v15, v38
    v_mul_f32_e32 v0, v0, v39
    s_waitcnt lgkmcnt(4)
    v_mfma_f32_32x32x16_bf16 v[48:63], v[20:23], v[184:187], v[48:63]
    ds_read_b64_tr_b16 v[16:17], v2 offset:20480
    ds_read_b64_tr_b16 v[18:19], v2 offset:20992
    v_cvt_pk_bf16_f32 v83, v15, v0
    ds_read_b128 v[36:39], v8 offset:1056
    v_mul_f32_e32 v13, v40, v40
    v_mfma_f32_32x32x16_bf16 v[48:63], v[24:27], v[188:191], v[48:63]
    ds_read_b64_tr_b16 v[20:21], v2 offset:22528
    ds_read_b64_tr_b16 v[22:23], v2 offset:23040
    v_mul_f32_e32 v14, v41, v41
    v_fma_f32 v13, v13, s37, v9
    v_fma_f32 v14, v14, s37, v9
    v_mul_f32_e32 v13, v13, v40
    s_setprio 0
    s_waitcnt lgkmcnt(5)
    v_mfma_f32_32x32x16_bf16 v[48:63], v[28:31], v[192:195], v[48:63]
    ds_read_b64_tr_b16 v[24:25], v3 offset:0
    ds_read_b64_tr_b16 v[26:27], v3 offset:512
    v_mul_f32_e32 v14, v14, v41
    v_exp_f32_e32 v13, v13
    v_exp_f32_e32 v14, v14
    v_add_f32_e32 v13, 1.0, v13
    v_mfma_f32_32x32x16_bf16 v[48:63], v[104:107], v[196:199], v[48:63]
    ds_read_b64_tr_b16 v[28:29], v3 offset:2048
    ds_read_b64_tr_b16 v[30:31], v3 offset:2560
    v_add_f32_e32 v14, 1.0, v14
    v_rcp_f32_e32 v13, v13
    v_rcp_f32_e32 v14, v14
    v_mul_f32_e32 v13, v13, v40
    s_waitcnt lgkmcnt(4)
    v_mfma_f32_32x32x16_bf16 v[48:63], v[16:19], v[200:203], v[48:63]
    ds_read_b64_tr_b16 v[104:105], v3 offset:4096
    ds_read_b64_tr_b16 v[106:107], v3 offset:4608
    v_mul_f32_e32 v14, v14, v41
    v_cvt_pk_bf16_f32 v84, v13, v14
    v_mul_f32_e32 v15, v42, v42
    v_mfma_f32_32x32x16_bf16 v[48:63], v[20:23], v[204:207], v[48:63]
    ds_read_b64_tr_b16 v[16:17], v3 offset:6144
    ds_read_b64_tr_b16 v[18:19], v3 offset:6656
    v_mul_f32_e32 v0, v43, v43
    v_fma_f32 v15, v15, s37, v9
    v_fma_f32 v0, v0, s37, v9
    v_mul_f32_e32 v15, v15, v42
    s_waitcnt vmcnt(9)
    s_barrier
    v_add_u32 v2, 0, v4
    s_setprio 2
    s_waitcnt lgkmcnt(4)
    v_mfma_f32_32x32x16_bf16 v[48:63], v[24:27], v[208:211], v[48:63]
    ds_read_b64_tr_b16 v[20:21], v3 offset:8192
    ds_read_b64_tr_b16 v[22:23], v3 offset:8704
    s_add_u32 m0, s65, 122880
    s_add_u32 s36, s49, 1769472
    buffer_load_dwordx4 v6, s[8:11], s36 offen  lds
    v_mul_f32_e32 v0, v0, v43
    v_exp_f32_e32 v15, v15
    v_exp_f32_e32 v0, v0
    v_add_f32_e32 v15, 1.0, v15
    v_mfma_f32_32x32x16_bf16 v[48:63], v[28:31], v[212:215], v[48:63]
    ds_read_b64_tr_b16 v[24:25], v3 offset:10240
    ds_read_b64_tr_b16 v[26:27], v3 offset:10752
    s_add_u32 m0, s65, 123904
    s_add_u32 s36, s49, 1843200
    buffer_load_dwordx4 v6, s[8:11], s36 offen  lds
    v_add_f32_e32 v0, 1.0, v0
    v_rcp_f32_e32 v15, v15
    v_rcp_f32_e32 v0, v0
    v_mul_f32_e32 v15, v15, v42
    s_waitcnt lgkmcnt(4)
    v_mfma_f32_32x32x16_bf16 v[48:63], v[104:107], v[216:219], v[48:63]
    ds_read_b64_tr_b16 v[28:29], v3 offset:12288
    ds_read_b64_tr_b16 v[30:31], v3 offset:12800
    s_add_u32 m0, s65, 124928
    s_add_u32 s36, s49, 1916928
    buffer_load_dwordx4 v6, s[8:11], s36 offen  lds
    v_mul_f32_e32 v0, v0, v43
    v_cvt_pk_bf16_f32 v85, v15, v0
    ds_read_b128 v[40:43], v8 offset:1088
    v_mfma_f32_32x32x16_bf16 v[48:63], v[16:19], v[220:223], v[48:63]
    ds_read_b64_tr_b16 v[104:105], v3 offset:14336
    ds_read_b64_tr_b16 v[106:107], v3 offset:14848
    v_mul_f32_e32 v13, v44, v44
    v_mul_f32_e32 v14, v45, v45
    v_fma_f32 v13, v13, s37, v9
    v_fma_f32 v14, v14, s37, v9
    s_setprio 1
    s_waitcnt lgkmcnt(5)
    v_mfma_f32_32x32x16_bf16 v[48:63], v[20:23], v[224:227], v[48:63]
    ds_read_b64_tr_b16 v[16:17], v3 offset:16384
    ds_read_b64_tr_b16 v[18:19], v3 offset:16896
    v_mul_f32_e32 v13, v13, v44
    v_mul_f32_e32 v14, v14, v45
    v_exp_f32_e32 v13, v13
    v_exp_f32_e32 v14, v14
    v_mfma_f32_32x32x16_bf16 v[48:63], v[24:27], v[228:231], v[48:63]
    ds_read_b64_tr_b16 v[20:21], v3 offset:18432
    ds_read_b64_tr_b16 v[22:23], v3 offset:18944
    v_add_f32_e32 v13, 1.0, v13
    v_add_f32_e32 v14, 1.0, v14
    v_rcp_f32_e32 v13, v13
    v_rcp_f32_e32 v14, v14
    s_waitcnt lgkmcnt(4)
    v_mfma_f32_32x32x16_bf16 v[48:63], v[28:31], v[232:235], v[48:63]
    ds_read_b64_tr_b16 v[24:25], v3 offset:20480
    ds_read_b64_tr_b16 v[26:27], v3 offset:20992
    v_mul_f32_e32 v13, v13, v44
    v_mul_f32_e32 v14, v14, v45
    v_cvt_pk_bf16_f32 v86, v13, v14
    v_mfma_f32_32x32x16_bf16 v[48:63], v[104:107], v[236:239], v[48:63]
    ds_read_b64_tr_b16 v[28:29], v3 offset:22528
    ds_read_b64_tr_b16 v[30:31], v3 offset:23040
    v_mul_f32_e32 v15, v46, v46
    v_mul_f32_e32 v0, v47, v47
    v_fma_f32 v15, v15, s37, v9
    v_fma_f32 v0, v0, s37, v9
    s_setprio 0
    s_waitcnt lgkmcnt(4)
    v_mfma_f32_32x32x16_bf16 v[48:63], v[16:19], v[240:243], v[48:63]
    ds_read_b64_tr_b16 v[104:105], v2 offset:0
    ds_read_b64_tr_b16 v[106:107], v2 offset:512
    v_mul_f32_e32 v15, v15, v46
    v_mul_f32_e32 v0, v0, v47
    v_exp_f32_e32 v15, v15
    v_exp_f32_e32 v0, v0
    v_mfma_f32_32x32x16_bf16 v[48:63], v[20:23], v[244:247], v[48:63]
    ds_read_b64_tr_b16 v[16:17], v2 offset:2048
    ds_read_b64_tr_b16 v[18:19], v2 offset:2560
    v_add_f32_e32 v15, 1.0, v15
    v_add_f32_e32 v0, 1.0, v0
    v_rcp_f32_e32 v15, v15
    v_rcp_f32_e32 v0, v0
    s_waitcnt lgkmcnt(4)
    v_mfma_f32_32x32x16_bf16 v[48:63], v[24:27], v[248:251], v[48:63]
    ds_read_b64_tr_b16 v[20:21], v2 offset:4096
    ds_read_b64_tr_b16 v[22:23], v2 offset:4608
    v_mul_f32_e32 v15, v15, v46
    v_mul_f32_e32 v0, v0, v47
    v_cvt_pk_bf16_f32 v87, v15, v0
    ds_read_b128 v[44:47], v8 offset:1120
    v_mfma_f32_32x32x16_bf16 v[48:63], v[28:31], v[252:255], v[48:63]
    ds_read_b64_tr_b16 v[24:25], v2 offset:6144
    ds_read_b64_tr_b16 v[26:27], v2 offset:6656
    s_waitcnt vmcnt(9)
    s_barrier
    v_add_u32 v3, 24576, v4
    s_setprio 2
    s_waitcnt lgkmcnt(5)
    s_waitcnt lgkmcnt(2)
    v_mfma_f32_32x32x16_bf16 v[32:47], v[104:107], v[112:115], v[32:47]
    ds_read_b64_tr_b16 v[28:29], v2 offset:8192
    ds_read_b64_tr_b16 v[30:31], v2 offset:8704
    s_add_u32 m0, s65, 73728
    s_add_u32 s36, s49, 3538944
    buffer_load_dwordx4 v6, s[8:11], s36 offen  lds
    v_mfma_f32_32x32x16_bf16 v[32:47], v[16:19], v[116:119], v[32:47]
    ds_read_b64_tr_b16 v[104:105], v2 offset:10240
    ds_read_b64_tr_b16 v[106:107], v2 offset:10752
    s_add_u32 m0, s65, 74752
    s_add_u32 s36, s49, 3612672
    buffer_load_dwordx4 v6, s[8:11], s36 offen  lds
    s_waitcnt lgkmcnt(4)
    v_mfma_f32_32x32x16_bf16 v[32:47], v[20:23], v[120:123], v[32:47]
    ds_read_b64_tr_b16 v[16:17], v2 offset:12288
    ds_read_b64_tr_b16 v[18:19], v2 offset:12800
    s_add_u32 m0, s65, 75776
    s_add_u32 s36, s49, 3686400
    buffer_load_dwordx4 v6, s[8:11], s36 offen  lds
    v_mul_f32_e32 v13, v48, v48
    v_mul_f32_e32 v14, v49, v49
    v_fma_f32 v13, v13, s37, v9
    v_mfma_f32_32x32x16_bf16 v[32:47], v[24:27], v[124:127], v[32:47]
    ds_read_b64_tr_b16 v[20:21], v2 offset:14336
    ds_read_b64_tr_b16 v[22:23], v2 offset:14848
    v_fma_f32 v14, v14, s37, v9
    v_mul_f32_e32 v13, v13, v48
    v_mul_f32_e32 v14, v14, v49
    v_exp_f32_e32 v13, v13
    s_setprio 1
    s_waitcnt lgkmcnt(4)
    v_mfma_f32_32x32x16_bf16 v[32:47], v[28:31], v[128:131], v[32:47]
    ds_read_b64_tr_b16 v[24:25], v2 offset:16384
    ds_read_b64_tr_b16 v[26:27], v2 offset:16896
    v_exp_f32_e32 v14, v14
    v_add_f32_e32 v13, 1.0, v13
    v_add_f32_e32 v14, 1.0, v14
    v_rcp_f32_e32 v13, v13
    v_mfma_f32_32x32x16_bf16 v[32:47], v[104:107], v[132:135], v[32:47]
    ds_read_b64_tr_b16 v[28:29], v2 offset:18432
    ds_read_b64_tr_b16 v[30:31], v2 offset:18944
    v_rcp_f32_e32 v14, v14
    v_mul_f32_e32 v13, v13, v48
    v_mul_f32_e32 v14, v14, v49
    v_cvt_pk_bf16_f32 v88, v13, v14
    s_waitcnt lgkmcnt(4)
    v_mfma_f32_32x32x16_bf16 v[32:47], v[16:19], v[136:139], v[32:47]
    ds_read_b64_tr_b16 v[104:105], v2 offset:20480
    ds_read_b64_tr_b16 v[106:107], v2 offset:20992
    v_mul_f32_e32 v15, v50, v50
    v_mul_f32_e32 v0, v51, v51
    v_fma_f32 v15, v15, s37, v9
    v_mfma_f32_32x32x16_bf16 v[32:47], v[20:23], v[140:143], v[32:47]
    ds_read_b64_tr_b16 v[16:17], v2 offset:22528
    ds_read_b64_tr_b16 v[18:19], v2 offset:23040
    v_fma_f32 v0, v0, s37, v9
    v_mul_f32_e32 v15, v15, v50
    v_mul_f32_e32 v0, v0, v51
    v_exp_f32_e32 v15, v15
    s_setprio 0
    s_waitcnt lgkmcnt(4)
    v_mfma_f32_32x32x16_bf16 v[32:47], v[24:27], v[144:147], v[32:47]
    ds_read_b64_tr_b16 v[20:21], v3 offset:0
    ds_read_b64_tr_b16 v[22:23], v3 offset:512
    v_exp_f32_e32 v0, v0
    v_add_f32_e32 v15, 1.0, v15
    v_add_f32_e32 v0, 1.0, v0
    v_rcp_f32_e32 v15, v15
    v_mfma_f32_32x32x16_bf16 v[32:47], v[28:31], v[148:151], v[32:47]
    ds_read_b64_tr_b16 v[24:25], v3 offset:2048
    ds_read_b64_tr_b16 v[26:27], v3 offset:2560
    v_rcp_f32_e32 v0, v0
    v_mul_f32_e32 v15, v15, v50
    v_mul_f32_e32 v0, v0, v51
    v_cvt_pk_bf16_f32 v89, v15, v0
    s_waitcnt lgkmcnt(4)
    v_mfma_f32_32x32x16_bf16 v[32:47], v[104:107], v[152:155], v[32:47]
    ds_read_b64_tr_b16 v[28:29], v3 offset:4096
    ds_read_b64_tr_b16 v[30:31], v3 offset:4608
    ds_read_b128 v[48:51], v8 offset:1280
    v_mul_f32_e32 v13, v52, v52
    v_mul_f32_e32 v14, v53, v53
    v_mfma_f32_32x32x16_bf16 v[32:47], v[16:19], v[156:159], v[32:47]
    ds_read_b64_tr_b16 v[104:105], v3 offset:6144
    ds_read_b64_tr_b16 v[106:107], v3 offset:6656
    v_fma_f32 v13, v13, s37, v9
    v_fma_f32 v14, v14, s37, v9
    v_mul_f32_e32 v13, v13, v52
    v_mul_f32_e32 v14, v14, v53
    s_waitcnt vmcnt(9)
    s_barrier
    v_add_u32 v2, 49152, v4
    s_setprio 2
    s_waitcnt lgkmcnt(5)
    v_mfma_f32_32x32x16_bf16 v[32:47], v[20:23], v[160:163], v[32:47]
    ds_read_b64_tr_b16 v[16:17], v3 offset:8192
    ds_read_b64_tr_b16 v[18:19], v3 offset:8704
    s_add_u32 m0, s65, 0
    s_add_u32 s36, s50, s56
    buffer_load_dwordx4 v7, s[12:15], s36 offen  lds
    v_exp_f32_e32 v13, v13
    v_exp_f32_e32 v14, v14
    v_add_f32_e32 v13, 1.0, v13
    v_add_f32_e32 v14, 1.0, v14
    v_mfma_f32_32x32x16_bf16 v[32:47], v[24:27], v[164:167], v[32:47]
    ds_read_b64_tr_b16 v[20:21], v3 offset:10240
    ds_read_b64_tr_b16 v[22:23], v3 offset:10752
    s_add_u32 m0, s65, 1024
    s_add_u32 s36, s51, s56
    buffer_load_dwordx4 v7, s[12:15], s36 offen  lds
    v_rcp_f32_e32 v13, v13
    v_rcp_f32_e32 v14, v14
    v_mul_f32_e32 v13, v13, v52
    v_mul_f32_e32 v14, v14, v53
    s_waitcnt lgkmcnt(4)
    v_mfma_f32_32x32x16_bf16 v[32:47], v[28:31], v[168:171], v[32:47]
    ds_read_b64_tr_b16 v[24:25], v3 offset:12288
    ds_read_b64_tr_b16 v[26:27], v3 offset:12800
    s_add_u32 m0, s65, 2048
    s_add_u32 s36, s52, s56
    buffer_load_dwordx4 v7, s[12:15], s36 offen  lds
    v_cvt_pk_bf16_f32 v90, v13, v14
    v_mul_f32_e32 v15, v54, v54
    v_mul_f32_e32 v0, v55, v55
    v_mfma_f32_32x32x16_bf16 v[32:47], v[104:107], v[172:175], v[32:47]
    ds_read_b64_tr_b16 v[28:29], v3 offset:14336
    ds_read_b64_tr_b16 v[30:31], v3 offset:14848
    v_fma_f32 v15, v15, s37, v9
    v_fma_f32 v0, v0, s37, v9
    v_mul_f32_e32 v15, v15, v54
    v_mul_f32_e32 v0, v0, v55
    s_setprio 1
    s_waitcnt lgkmcnt(4)
    v_mfma_f32_32x32x16_bf16 v[32:47], v[16:19], v[176:179], v[32:47]
    ds_read_b64_tr_b16 v[104:105], v3 offset:16384
    ds_read_b64_tr_b16 v[106:107], v3 offset:16896
    v_exp_f32_e32 v15, v15
    v_exp_f32_e32 v0, v0
    v_add_f32_e32 v15, 1.0, v15
    v_add_f32_e32 v0, 1.0, v0
    v_mfma_f32_32x32x16_bf16 v[32:47], v[20:23], v[180:183], v[32:47]
    ds_read_b64_tr_b16 v[16:17], v3 offset:18432
    ds_read_b64_tr_b16 v[18:19], v3 offset:18944
    v_rcp_f32_e32 v15, v15
    v_rcp_f32_e32 v0, v0
    v_mul_f32_e32 v15, v15, v54
    v_mul_f32_e32 v0, v0, v55
    s_waitcnt lgkmcnt(4)
    v_mfma_f32_32x32x16_bf16 v[32:47], v[24:27], v[184:187], v[32:47]
    ds_read_b64_tr_b16 v[20:21], v3 offset:20480
    ds_read_b64_tr_b16 v[22:23], v3 offset:20992
    v_cvt_pk_bf16_f32 v91, v15, v0
    ds_read_b128 v[52:55], v8 offset:1312
    v_mul_f32_e32 v13, v56, v56
    v_mfma_f32_32x32x16_bf16 v[32:47], v[28:31], v[188:191], v[32:47]
    ds_read_b64_tr_b16 v[24:25], v3 offset:22528
    ds_read_b64_tr_b16 v[26:27], v3 offset:23040
    v_mul_f32_e32 v14, v57, v57
    v_fma_f32 v13, v13, s37, v9
    v_fma_f32 v14, v14, s37, v9
    v_mul_f32_e32 v13, v13, v56
    s_setprio 0
    s_waitcnt lgkmcnt(5)
    v_mfma_f32_32x32x16_bf16 v[32:47], v[104:107], v[192:195], v[32:47]
    ds_read_b64_tr_b16 v[28:29], v2 offset:0
    ds_read_b64_tr_b16 v[30:31], v2 offset:512
    v_mul_f32_e32 v14, v14, v57
    v_exp_f32_e32 v13, v13
    v_exp_f32_e32 v14, v14
    v_add_f32_e32 v13, 1.0, v13
    v_mfma_f32_32x32x16_bf16 v[32:47], v[16:19], v[196:199], v[32:47]
    ds_read_b64_tr_b16 v[104:105], v2 offset:2048
    ds_read_b64_tr_b16 v[106:107], v2 offset:2560
    v_add_f32_e32 v14, 1.0, v14
    v_rcp_f32_e32 v13, v13
    v_rcp_f32_e32 v14, v14
    v_mul_f32_e32 v13, v13, v56
    s_waitcnt lgkmcnt(4)
    v_mfma_f32_32x32x16_bf16 v[32:47], v[20:23], v[200:203], v[32:47]
    ds_read_b64_tr_b16 v[16:17], v2 offset:4096
    ds_read_b64_tr_b16 v[18:19], v2 offset:4608
    v_mul_f32_e32 v14, v14, v57
    v_cvt_pk_bf16_f32 v92, v13, v14
    v_mul_f32_e32 v15, v58, v58
    v_mfma_f32_32x32x16_bf16 v[32:47], v[24:27], v[204:207], v[32:47]
    ds_read_b64_tr_b16 v[20:21], v2 offset:6144
    ds_read_b64_tr_b16 v[22:23], v2 offset:6656
    v_mul_f32_e32 v0, v59, v59
    v_fma_f32 v15, v15, s37, v9
    v_fma_f32 v0, v0, s37, v9
    v_mul_f32_e32 v15, v15, v58
    s_waitcnt vmcnt(9)
    s_barrier
    v_add_u32 v3, 98304, v4
    s_setprio 2
    s_waitcnt lgkmcnt(4)
    v_mfma_f32_32x32x16_bf16 v[32:47], v[28:31], v[208:211], v[32:47]
    ds_read_b64_tr_b16 v[24:25], v2 offset:8192
    ds_read_b64_tr_b16 v[26:27], v2 offset:8704
    s_add_u32 m0, s65, 24576
    s_add_u32 s36, s50, s57
    buffer_load_dwordx4 v7, s[12:15], s36 offen  lds
    v_mul_f32_e32 v0, v0, v59
    v_exp_f32_e32 v15, v15
    v_exp_f32_e32 v0, v0
    v_add_f32_e32 v15, 1.0, v15
    v_mfma_f32_32x32x16_bf16 v[32:47], v[104:107], v[212:215], v[32:47]
    ds_read_b64_tr_b16 v[28:29], v2 offset:10240
    ds_read_b64_tr_b16 v[30:31], v2 offset:10752
    s_add_u32 m0, s65, 25600
    s_add_u32 s36, s51, s57
    buffer_load_dwordx4 v7, s[12:15], s36 offen  lds
    v_add_f32_e32 v0, 1.0, v0
    v_rcp_f32_e32 v15, v15
    v_rcp_f32_e32 v0, v0
    v_mul_f32_e32 v15, v15, v58
    s_waitcnt lgkmcnt(4)
    v_mfma_f32_32x32x16_bf16 v[32:47], v[16:19], v[216:219], v[32:47]
    ds_read_b64_tr_b16 v[104:105], v2 offset:12288
    ds_read_b64_tr_b16 v[106:107], v2 offset:12800
    s_add_u32 m0, s65, 26624
    s_add_u32 s36, s52, s57
    buffer_load_dwordx4 v7, s[12:15], s36 offen  lds
    v_mul_f32_e32 v0, v0, v59
    v_cvt_pk_bf16_f32 v93, v15, v0
    ds_read_b128 v[56:59], v8 offset:1344
    v_mfma_f32_32x32x16_bf16 v[32:47], v[20:23], v[220:223], v[32:47]
    ds_read_b64_tr_b16 v[16:17], v2 offset:14336
    ds_read_b64_tr_b16 v[18:19], v2 offset:14848
    v_mul_f32_e32 v13, v60, v60
    v_mul_f32_e32 v14, v61, v61
    v_fma_f32 v13, v13, s37, v9
    v_fma_f32 v14, v14, s37, v9
    s_setprio 1
    s_waitcnt lgkmcnt(5)
    v_mfma_f32_32x32x16_bf16 v[32:47], v[24:27], v[224:227], v[32:47]
    ds_read_b64_tr_b16 v[20:21], v2 offset:16384
    ds_read_b64_tr_b16 v[22:23], v2 offset:16896
    v_mul_f32_e32 v13, v13, v60
    v_mul_f32_e32 v14, v14, v61
    v_exp_f32_e32 v13, v13
    v_exp_f32_e32 v14, v14
    v_mfma_f32_32x32x16_bf16 v[32:47], v[28:31], v[228:231], v[32:47]
    ds_read_b64_tr_b16 v[24:25], v2 offset:18432
    ds_read_b64_tr_b16 v[26:27], v2 offset:18944
    v_add_f32_e32 v13, 1.0, v13
    v_add_f32_e32 v14, 1.0, v14
    v_rcp_f32_e32 v13, v13
    v_rcp_f32_e32 v14, v14
    s_waitcnt lgkmcnt(4)
    v_mfma_f32_32x32x16_bf16 v[32:47], v[104:107], v[232:235], v[32:47]
    ds_read_b64_tr_b16 v[28:29], v2 offset:20480
    ds_read_b64_tr_b16 v[30:31], v2 offset:20992
    v_mul_f32_e32 v13, v13, v60
    v_mul_f32_e32 v14, v14, v61
    v_cvt_pk_bf16_f32 v94, v13, v14
    v_mfma_f32_32x32x16_bf16 v[32:47], v[16:19], v[236:239], v[32:47]
    ds_read_b64_tr_b16 v[104:105], v2 offset:22528
    ds_read_b64_tr_b16 v[106:107], v2 offset:23040
    v_mul_f32_e32 v15, v62, v62
    v_mul_f32_e32 v0, v63, v63
    v_fma_f32 v15, v15, s37, v9
    v_fma_f32 v0, v0, s37, v9
    s_setprio 0
    s_waitcnt lgkmcnt(4)
    v_mfma_f32_32x32x16_bf16 v[32:47], v[20:23], v[240:243], v[32:47]
    ds_read_b64_tr_b16 v[16:17], v3 offset:0
    ds_read_b64_tr_b16 v[18:19], v3 offset:512
    v_mul_f32_e32 v15, v15, v62
    v_mul_f32_e32 v0, v0, v63
    v_exp_f32_e32 v15, v15
    v_exp_f32_e32 v0, v0
    v_mfma_f32_32x32x16_bf16 v[32:47], v[24:27], v[244:247], v[32:47]
    ds_read_b64_tr_b16 v[20:21], v3 offset:2048
    ds_read_b64_tr_b16 v[22:23], v3 offset:2560
    v_add_f32_e32 v15, 1.0, v15
    v_add_f32_e32 v0, 1.0, v0
    v_rcp_f32_e32 v15, v15
    v_rcp_f32_e32 v0, v0
    s_waitcnt lgkmcnt(4)
    v_mfma_f32_32x32x16_bf16 v[32:47], v[28:31], v[248:251], v[32:47]
    ds_read_b64_tr_b16 v[24:25], v3 offset:4096
    ds_read_b64_tr_b16 v[26:27], v3 offset:4608
    v_mul_f32_e32 v15, v15, v62
    v_mul_f32_e32 v0, v0, v63
    v_cvt_pk_bf16_f32 v95, v15, v0
    ds_read_b128 v[60:63], v8 offset:1376
    v_mfma_f32_32x32x16_bf16 v[32:47], v[104:107], v[252:255], v[32:47]
    ds_read_b64_tr_b16 v[28:29], v3 offset:6144
    ds_read_b64_tr_b16 v[30:31], v3 offset:6656
    s_waitcnt vmcnt(9)
    s_barrier
    v_add_u32 v2, 122880, v4
    s_setprio 2
    s_waitcnt lgkmcnt(5)
    s_waitcnt lgkmcnt(2)
    v_mfma_f32_32x32x16_bf16 v[48:63], v[16:19], v[112:115], v[48:63]
    ds_read_b64_tr_b16 v[104:105], v3 offset:8192
    ds_read_b64_tr_b16 v[106:107], v3 offset:8704
    v_mfma_f32_32x32x16_bf16 v[48:63], v[20:23], v[116:119], v[48:63]
    ds_read_b64_tr_b16 v[16:17], v3 offset:10240
    ds_read_b64_tr_b16 v[18:19], v3 offset:10752
    s_waitcnt lgkmcnt(4)
    v_mfma_f32_32x32x16_bf16 v[48:63], v[24:27], v[120:123], v[48:63]
    ds_read_b64_tr_b16 v[20:21], v3 offset:12288
    ds_read_b64_tr_b16 v[22:23], v3 offset:12800
    v_mul_f32_e32 v13, v32, v32
    v_mul_f32_e32 v14, v33, v33
    v_fma_f32 v13, v13, s37, v9
    v_mfma_f32_32x32x16_bf16 v[48:63], v[28:31], v[124:127], v[48:63]
    ds_read_b64_tr_b16 v[24:25], v3 offset:14336
    ds_read_b64_tr_b16 v[26:27], v3 offset:14848
    v_fma_f32 v14, v14, s37, v9
    v_mul_f32_e32 v13, v13, v32
    v_mul_f32_e32 v14, v14, v33
    v_exp_f32_e32 v13, v13
    s_setprio 1
    s_waitcnt lgkmcnt(4)
    v_mfma_f32_32x32x16_bf16 v[48:63], v[104:107], v[128:131], v[48:63]
    ds_read_b64_tr_b16 v[28:29], v3 offset:16384
    ds_read_b64_tr_b16 v[30:31], v3 offset:16896
    v_exp_f32_e32 v14, v14
    v_add_f32_e32 v13, 1.0, v13
    v_add_f32_e32 v14, 1.0, v14
    v_mfma_f32_32x32x16_bf16 v[48:63], v[16:19], v[132:135], v[48:63]
    ds_read_b64_tr_b16 v[104:105], v3 offset:18432
    ds_read_b64_tr_b16 v[106:107], v3 offset:18944
    v_rcp_f32_e32 v13, v13
    v_rcp_f32_e32 v14, v14
    v_mul_f32_e32 v13, v13, v32
    v_mul_f32_e32 v14, v14, v33
    s_waitcnt lgkmcnt(4)
    v_mfma_f32_32x32x16_bf16 v[48:63], v[20:23], v[136:139], v[48:63]
    ds_read_b64_tr_b16 v[16:17], v3 offset:20480
    ds_read_b64_tr_b16 v[18:19], v3 offset:20992
    v_cvt_pk_bf16_f32 v96, v13, v14
    v_mul_f32_e32 v15, v34, v34
    v_mul_f32_e32 v0, v35, v35
    v_fma_f32 v15, v15, s37, v9
    v_mfma_f32_32x32x16_bf16 v[48:63], v[24:27], v[140:143], v[48:63]
    ds_read_b64_tr_b16 v[20:21], v3 offset:22528
    ds_read_b64_tr_b16 v[22:23], v3 offset:23040
    v_fma_f32 v0, v0, s37, v9
    v_mul_f32_e32 v15, v15, v34
    v_mul_f32_e32 v0, v0, v35
    s_setprio 0
    s_waitcnt lgkmcnt(4)
    v_mfma_f32_32x32x16_bf16 v[48:63], v[28:31], v[144:147], v[48:63]
    ds_read_b64_tr_b16 v[24:25], v2 offset:0
    ds_read_b64_tr_b16 v[26:27], v2 offset:512
    v_exp_f32_e32 v15, v15
    v_exp_f32_e32 v0, v0
    v_add_f32_e32 v15, 1.0, v15
    v_add_f32_e32 v0, 1.0, v0
    v_mfma_f32_32x32x16_bf16 v[48:63], v[104:107], v[148:151], v[48:63]
    ds_read_b64_tr_b16 v[28:29], v2 offset:2048
    ds_read_b64_tr_b16 v[30:31], v2 offset:2560
    v_rcp_f32_e32 v15, v15
    v_rcp_f32_e32 v0, v0
    v_mul_f32_e32 v15, v15, v34
    v_mul_f32_e32 v0, v0, v35
    s_waitcnt lgkmcnt(4)
    v_mfma_f32_32x32x16_bf16 v[48:63], v[16:19], v[152:155], v[48:63]
    ds_read_b64_tr_b16 v[104:105], v2 offset:4096
    ds_read_b64_tr_b16 v[106:107], v2 offset:4608
    v_cvt_pk_bf16_f32 v97, v15, v0
    v_mul_f32_e32 v13, v36, v36
    v_mul_f32_e32 v14, v37, v37
    v_mfma_f32_32x32x16_bf16 v[48:63], v[20:23], v[156:159], v[48:63]
    ds_read_b64_tr_b16 v[16:17], v2 offset:6144
    ds_read_b64_tr_b16 v[18:19], v2 offset:6656
    v_fma_f32 v13, v13, s37, v9
    v_fma_f32 v14, v14, s37, v9
    v_mul_f32_e32 v13, v13, v36
    v_mul_f32_e32 v14, v14, v37
    s_waitcnt vmcnt(6)
    s_barrier
    v_add_u32 v3, 73728, v4
    v_lshlrev_b32 v10, 4, v1
    s_mul_i32 s42, s29, 6144
    s_mul_i32 s43, s30, 49152
    s_add_u32 s41, s43, 49152
    s_sub_u32 s43, 98304, s43
    s_add_u32 s41, s41, s42
    s_add_u32 s43, s43, s42
    v_add_u32 v8, s41, v10
    v_add_u32 v6, s43, v10
    s_setprio 2
    s_waitcnt lgkmcnt(4)
    v_mfma_f32_32x32x16_bf16 v[48:63], v[24:27], v[160:163], v[48:63]
    ds_read_b64_tr_b16 v[20:21], v2 offset:8192
    ds_read_b64_tr_b16 v[22:23], v2 offset:8704
    ds_write_b128 v8, v[64:67] offset:0
    v_exp_f32_e32 v13, v13
    v_exp_f32_e32 v14, v14
    v_add_f32_e32 v13, 1.0, v13
    v_add_f32_e32 v14, 1.0, v14
    v_mfma_f32_32x32x16_bf16 v[48:63], v[28:31], v[164:167], v[48:63]
    ds_read_b64_tr_b16 v[24:25], v2 offset:10240
    ds_read_b64_tr_b16 v[26:27], v2 offset:10752
    v_rcp_f32_e32 v13, v13
    v_rcp_f32_e32 v14, v14
    v_mul_f32_e32 v13, v13, v36
    s_waitcnt lgkmcnt(5)
    v_mfma_f32_32x32x16_bf16 v[48:63], v[104:107], v[168:171], v[48:63]
    ds_read_b64_tr_b16 v[28:29], v2 offset:12288
    ds_read_b64_tr_b16 v[30:31], v2 offset:12800
    ds_write_b128 v8, v[68:71] offset:1024
    v_mul_f32_e32 v14, v14, v37
    v_cvt_pk_bf16_f32 v98, v13, v14
    v_mul_f32_e32 v15, v38, v38
    v_mul_f32_e32 v0, v39, v39
    v_mfma_f32_32x32x16_bf16 v[48:63], v[16:19], v[172:175], v[48:63]
    ds_read_b64_tr_b16 v[104:105], v2 offset:14336
    ds_read_b64_tr_b16 v[106:107], v2 offset:14848
    v_fma_f32 v15, v15, s37, v9
    v_fma_f32 v0, v0, s37, v9
    v_mul_f32_e32 v15, v15, v38
    s_setprio 1
    s_waitcnt lgkmcnt(5)
    v_mfma_f32_32x32x16_bf16 v[48:63], v[20:23], v[176:179], v[48:63]
    ds_read_b64_tr_b16 v[16:17], v2 offset:16384
    ds_read_b64_tr_b16 v[18:19], v2 offset:16896
    ds_write_b128 v8, v[72:75] offset:2048
    v_mul_f32_e32 v0, v0, v39
    v_exp_f32_e32 v15, v15
    v_exp_f32_e32 v0, v0
    v_add_f32_e32 v15, 1.0, v15
    v_mfma_f32_32x32x16_bf16 v[48:63], v[24:27], v[180:183], v[48:63]
    ds_read_b64_tr_b16 v[20:21], v2 offset:18432
    ds_read_b64_tr_b16 v[22:23], v2 offset:18944
    v_add_f32_e32 v0, 1.0, v0
    v_rcp_f32_e32 v15, v15
    v_rcp_f32_e32 v0, v0
    v_mul_f32_e32 v15, v15, v38
    s_waitcnt lgkmcnt(5)
    v_mfma_f32_32x32x16_bf16 v[48:63], v[28:31], v[184:187], v[48:63]
    ds_read_b64_tr_b16 v[24:25], v2 offset:20480
    ds_read_b64_tr_b16 v[26:27], v2 offset:20992
    ds_write_b128 v8, v[76:79] offset:3072
    v_mul_f32_e32 v0, v0, v39
    v_cvt_pk_bf16_f32 v99, v15, v0
    v_mul_f32_e32 v13, v40, v40
    v_mfma_f32_32x32x16_bf16 v[48:63], v[104:107], v[188:191], v[48:63]
    ds_read_b64_tr_b16 v[28:29], v2 offset:22528
    ds_read_b64_tr_b16 v[30:31], v2 offset:23040
    v_mul_f32_e32 v14, v41, v41
    v_fma_f32 v13, v13, s37, v9
    v_fma_f32 v14, v14, s37, v9
    v_mul_f32_e32 v13, v13, v40
    s_setprio 0
    s_waitcnt lgkmcnt(5)
    v_mfma_f32_32x32x16_bf16 v[48:63], v[16:19], v[192:195], v[48:63]
    ds_read_b64_tr_b16 v[104:105], v3 offset:0
    ds_read_b64_tr_b16 v[106:107], v3 offset:512
    ds_write_b128 v8, v[80:83] offset:4096
    v_mul_f32_e32 v14, v14, v41
    v_exp_f32_e32 v13, v13
    v_exp_f32_e32 v14, v14
    v_add_f32_e32 v13, 1.0, v13
    v_mfma_f32_32x32x16_bf16 v[48:63], v[20:23], v[196:199], v[48:63]
    ds_read_b64_tr_b16 v[16:17], v3 offset:2048
    ds_read_b64_tr_b16 v[18:19], v3 offset:2560
    v_add_f32_e32 v14, 1.0, v14
    v_rcp_f32_e32 v13, v13
    v_rcp_f32_e32 v14, v14
    s_waitcnt lgkmcnt(5)
    v_mfma_f32_32x32x16_bf16 v[48:63], v[24:27], v[200:203], v[48:63]
    ds_read_b64_tr_b16 v[20:21], v3 offset:4096
    ds_read_b64_tr_b16 v[22:23], v3 offset:4608
    ds_write_b128 v8, v[84:87] offset:5120
    v_mul_f32_e32 v13, v13, v40
    v_mul_f32_e32 v14, v14, v41
    v_cvt_pk_bf16_f32 v100, v13, v14
    v_mul_f32_e32 v15, v42, v42
    v_mfma_f32_32x32x16_bf16 v[48:63], v[28:31], v[204:207], v[48:63]
    ds_read_b64_tr_b16 v[24:25], v3 offset:6144
    ds_read_b64_tr_b16 v[26:27], v3 offset:6656
    v_mul_f32_e32 v0, v43, v43
    v_fma_f32 v15, v15, s37, v9
    v_fma_f32 v0, v0, s37, v9
    v_mul_f32_e32 v15, v15, v42
    s_lshl_b32 s42, s30, 12
    s_xor_b32 s43, s42, 4096
    v_add_u32 v4, s42, v5
    v_add_u32 v5, s43, v5
    s_waitcnt vmcnt(3)
    s_waitcnt lgkmcnt(2)
    s_barrier
    v_add_u32 v2, 0, v4
    v_add_u32 v11, 0, v5
    s_setprio 2
    v_mfma_f32_32x32x16_bf16 v[48:63], v[104:107], v[208:211], v[48:63]
    ds_read_b64_tr_b16 v[28:29], v3 offset:8192
    ds_read_b64_tr_b16 v[30:31], v3 offset:8704
    s_add_u32 m0, s65, 122880
    s_add_u32 s36, s53, s56
    buffer_load_dwordx4 v7, s[12:15], s36 offen  lds
    s_mov_b32 s39, 0
    ds_read_b128 v[112:115], v6 offset:0
    v_mul_f32_e32 v0, v0, v43
    v_exp_f32_e32 v15, v15
    v_exp_f32_e32 v0, v0
    v_mfma_f32_32x32x16_bf16 v[48:63], v[16:19], v[212:215], v[48:63]
    ds_read_b64_tr_b16 v[104:105], v3 offset:10240
    ds_read_b64_tr_b16 v[106:107], v3 offset:10752
    s_add_u32 m0, s65, 123904
    s_add_u32 s36, s54, s56
    buffer_load_dwordx4 v7, s[12:15], s36 offen  lds
    v_mov_b32 v201, 0
    buffer_load_dword v200, v201, s[68:71], 0 offen offset:128 sc1
    ds_read_b128 v[116:119], v6 offset:1024
    v_add_f32_e32 v15, 1.0, v15
    v_add_f32_e32 v0, 1.0, v0
    v_rcp_f32_e32 v15, v15
    v_rcp_f32_e32 v0, v0
    s_waitcnt lgkmcnt(6)
    v_mfma_f32_32x32x16_bf16 v[48:63], v[20:23], v[216:219], v[48:63]
    ds_read_b64_tr_b16 v[16:17], v3 offset:12288
    ds_read_b64_tr_b16 v[18:19], v3 offset:12800
    s_add_u32 m0, s65, 124928
    s_add_u32 s36, s55, s56
    buffer_load_dwordx4 v7, s[12:15], s36 offen  lds
    ds_read_b128 v[120:123], v6 offset:2048
    v_mul_f32_e32 v15, v15, v42
    v_mul_f32_e32 v0, v0, v43
    v_cvt_pk_bf16_f32 v101, v15, v0
    v_mfma_f32_32x32x16_bf16 v[48:63], v[24:27], v[220:223], v[48:63]
    ds_read_b64_tr_b16 v[20:21], v3 offset:14336
    ds_read_b64_tr_b16 v[22:23], v3 offset:14848
    ds_read_b128 v[124:127], v6 offset:3072
    v_mul_f32_e32 v13, v44, v44
    v_mul_f32_e32 v14, v45, v45
    v_fma_f32 v13, v13, s37, v9
    v_fma_f32 v14, v14, s37, v9
    s_setprio 1
    s_waitcnt lgkmcnt(7)
    v_mfma_f32_32x32x16_bf16 v[48:63], v[28:31], v[224:227], v[48:63]
    ds_read_b64_tr_b16 v[24:25], v3 offset:16384
    ds_read_b64_tr_b16 v[26:27], v3 offset:16896
    ds_read_b128 v[128:131], v6 offset:4096
    v_mul_f32_e32 v13, v13, v44
    v_mul_f32_e32 v14, v14, v45
    v_exp_f32_e32 v13, v13
    v_exp_f32_e32 v14, v14
    v_mfma_f32_32x32x16_bf16 v[48:63], v[104:107], v[228:231], v[48:63]
    ds_read_b64_tr_b16 v[28:29], v3 offset:18432
    ds_read_b64_tr_b16 v[30:31], v3 offset:18944
    ds_read_b128 v[132:135], v6 offset:5120
    v_add_f32_e32 v13, 1.0, v13
    v_add_f32_e32 v14, 1.0, v14
    v_rcp_f32_e32 v13, v13
    s_waitcnt lgkmcnt(7)
    v_mfma_f32_32x32x16_bf16 v[48:63], v[16:19], v[232:235], v[48:63]
    ds_read_b64_tr_b16 v[104:105], v3 offset:20480
    ds_read_b64_tr_b16 v[106:107], v3 offset:20992
    v_rcp_f32_e32 v14, v14
    v_mul_f32_e32 v13, v13, v44
    v_mul_f32_e32 v14, v14, v45
    v_cvt_pk_bf16_f32 v102, v13, v14
    v_mfma_f32_32x32x16_bf16 v[48:63], v[20:23], v[236:239], v[48:63]
    ds_read_b64_tr_b16 v[16:17], v3 offset:22528
    ds_read_b64_tr_b16 v[18:19], v3 offset:23040
    v_mul_f32_e32 v15, v46, v46
    v_mul_f32_e32 v0, v47, v47
    v_fma_f32 v15, v15, s37, v9
    v_fma_f32 v0, v0, s37, v9
    s_setprio 0
    s_waitcnt lgkmcnt(5)
    v_mfma_f32_32x32x16_bf16 v[48:63], v[24:27], v[240:243], v[48:63]
    ds_read_b64_tr_b16 v[20:21], v2 offset:0
    ds_read_b64_tr_b16 v[22:23], v2 offset:1024
    v_mul_f32_e32 v15, v15, v46
    v_mul_f32_e32 v0, v0, v47
    v_exp_f32_e32 v15, v15
    v_mfma_f32_32x32x16_bf16 v[48:63], v[28:31], v[244:247], v[48:63]
    ds_read_b64_tr_b16 v[24:25], v2 offset:2048
    ds_read_b64_tr_b16 v[26:27], v2 offset:3072
    v_exp_f32_e32 v0, v0
    v_add_f32_e32 v15, 1.0, v15
    v_add_f32_e32 v0, 1.0, v0
    v_rcp_f32_e32 v15, v15
    s_waitcnt lgkmcnt(4)
    v_mfma_f32_32x32x16_bf16 v[48:63], v[104:107], v[248:251], v[48:63]
    s_waitcnt vmcnt(4)
    s_barrier
    ds_read_b64_tr_b16 v[28:29], v2 offset:8192
    ds_read_b64_tr_b16 v[30:31], v2 offset:9216
    v_rcp_f32_e32 v0, v0
    v_mul_f32_e32 v15, v15, v46
    v_mul_f32_e32 v0, v0, v47
    v_cvt_pk_bf16_f32 v103, v15, v0
    v_mfma_f32_32x32x16_bf16 v[48:63], v[16:19], v[252:255], v[48:63]
    ds_read_b64_tr_b16 v[204:205], v2 offset:10240
    ds_read_b64_tr_b16 v[206:207], v2 offset:11264
    v_add_u32 v3, 24576, v4
    v_add_u32 v12, 24576, v5
    s_setprio 2
    s_waitcnt lgkmcnt(4)
    v_mfma_f32_32x32x16_bf16 v[168:183], v[20:23], v[64:67], 0
    ds_read_b64_tr_b16 v[16:17], v2 offset:16384
    ds_read_b64_tr_b16 v[18:19], v2 offset:17408
    s_add_u32 m0, s65, 73728
    s_add_u32 s36, s53, s57
    buffer_load_dwordx4 v7, s[12:15], s36 offen  lds
    v_mfma_f32_32x32x16_bf16 v[168:183], v[24:27], v[68:71], v[168:183]
    ds_read_b64_tr_b16 v[20:21], v2 offset:18432
    ds_read_b64_tr_b16 v[22:23], v2 offset:19456
    s_add_u32 m0, s65, 74752
    s_add_u32 s36, s54, s57
    buffer_load_dwordx4 v7, s[12:15], s36 offen  lds
    s_waitcnt lgkmcnt(4)
    v_mfma_f32_32x32x16_bf16 v[168:183], v[28:31], v[72:75], v[168:183]
    ds_read_b64_tr_b16 v[24:25], v11 offset:0
    ds_read_b64_tr_b16 v[26:27], v11 offset:1024
    s_add_u32 m0, s65, 75776
    s_add_u32 s36, s55, s57
    buffer_load_dwordx4 v7, s[12:15], s36 offen  lds
    v_mul_f32_e32 v13, v48, v48
    v_mul_f32_e32 v14, v49, v49
    v_fma_f32 v13, v13, s37, v9
    v_fma_f32 v14, v14, s37, v9
    v_mul_f32_e32 v13, v13, v48
    v_mul_f32_e32 v14, v14, v49
    v_mfma_f32_32x32x16_bf16 v[168:183], v[204:207], v[76:79], v[168:183]
    ds_read_b64_tr_b16 v[28:29], v11 offset:2048
    ds_read_b64_tr_b16 v[30:31], v11 offset:3072
    v_exp_f32_e32 v13, v13
    v_exp_f32_e32 v14, v14
    v_add_f32_e32 v13, 1.0, v13
    v_add_f32_e32 v14, 1.0, v14
    v_rcp_f32_e32 v13, v13
    v_rcp_f32_e32 v14, v14
    s_setprio 1
    s_waitcnt lgkmcnt(4)
    v_mfma_f32_32x32x16_bf16 v[168:183], v[16:19], v[80:83], v[168:183]
    ds_read_b64_tr_b16 v[204:205], v11 offset:8192
    ds_read_b64_tr_b16 v[206:207], v11 offset:9216
    v_mul_f32_e32 v13, v13, v48
    v_mul_f32_e32 v14, v14, v49
    v_cvt_pk_bf16_f32 v104, v13, v14
    v_mul_f32_e32 v15, v50, v50
    v_mul_f32_e32 v0, v51, v51
    v_fma_f32 v15, v15, s37, v9
    v_mfma_f32_32x32x16_bf16 v[168:183], v[20:23], v[84:87], v[168:183]
    ds_read_b64_tr_b16 v[16:17], v11 offset:10240
    ds_read_b64_tr_b16 v[18:19], v11 offset:11264
    v_fma_f32 v0, v0, s37, v9
    v_mul_f32_e32 v15, v15, v50
    v_mul_f32_e32 v0, v0, v51
    v_exp_f32_e32 v15, v15
    v_exp_f32_e32 v0, v0
    v_add_f32_e32 v15, 1.0, v15
    s_waitcnt lgkmcnt(4)
    v_mfma_f32_32x32x16_bf16 v[168:183], v[24:27], v[112:115], v[168:183]
    ds_read_b64_tr_b16 v[20:21], v11 offset:16384
    ds_read_b64_tr_b16 v[22:23], v11 offset:17408
    v_add_f32_e32 v0, 1.0, v0
    v_rcp_f32_e32 v15, v15
    v_rcp_f32_e32 v0, v0
    v_mul_f32_e32 v15, v15, v50
    v_mul_f32_e32 v0, v0, v51
    v_cvt_pk_bf16_f32 v105, v15, v0
    v_mfma_f32_32x32x16_bf16 v[168:183], v[28:31], v[116:119], v[168:183]
    ds_read_b64_tr_b16 v[24:25], v11 offset:18432
    ds_read_b64_tr_b16 v[26:27], v11 offset:19456
    v_mul_f32_e32 v13, v52, v52
    v_mul_f32_e32 v14, v53, v53
    v_fma_f32 v13, v13, s37, v9
    v_fma_f32 v14, v14, s37, v9
    v_mul_f32_e32 v13, v13, v52
    v_mul_f32_e32 v14, v14, v53
    s_setprio 0
    s_waitcnt lgkmcnt(4)
    v_mfma_f32_32x32x16_bf16 v[168:183], v[204:207], v[120:123], v[168:183]
    ds_read_b64_tr_b16 v[28:29], v3 offset:0
    ds_read_b64_tr_b16 v[30:31], v3 offset:1024
    v_exp_f32_e32 v13, v13
    v_exp_f32_e32 v14, v14
    v_add_f32_e32 v13, 1.0, v13
    v_add_f32_e32 v14, 1.0, v14
    v_rcp_f32_e32 v13, v13
    v_rcp_f32_e32 v14, v14
    v_mfma_f32_32x32x16_bf16 v[168:183], v[16:19], v[124:127], v[168:183]
    ds_read_b64_tr_b16 v[204:205], v3 offset:2048
    ds_read_b64_tr_b16 v[206:207], v3 offset:3072
    v_mul_f32_e32 v13, v13, v52
    v_mul_f32_e32 v14, v14, v53
    v_cvt_pk_bf16_f32 v106, v13, v14
    v_mul_f32_e32 v15, v54, v54
    v_mul_f32_e32 v0, v55, v55
    v_fma_f32 v15, v15, s37, v9
    s_waitcnt lgkmcnt(4)
    v_mfma_f32_32x32x16_bf16 v[168:183], v[20:23], v[128:131], v[168:183]
    s_waitcnt vmcnt(3)
    s_barrier
    ds_read_b64_tr_b16 v[16:17], v3 offset:8192
    ds_read_b64_tr_b16 v[18:19], v3 offset:9216
    v_fma_f32 v0, v0, s37, v9
    v_mul_f32_e32 v15, v15, v54
    v_mul_f32_e32 v0, v0, v55
    v_exp_f32_e32 v15, v15
    v_exp_f32_e32 v0, v0
    v_add_f32_e32 v15, 1.0, v15
    v_mfma_f32_32x32x16_bf16 v[168:183], v[24:27], v[132:135], v[168:183]
    ds_read_b64_tr_b16 v[20:21], v3 offset:10240
    ds_read_b64_tr_b16 v[22:23], v3 offset:11264
    v_add_f32_e32 v0, 1.0, v0
    v_rcp_f32_e32 v15, v15
    v_rcp_f32_e32 v0, v0
    v_mul_f32_e32 v15, v15, v54
    v_mul_f32_e32 v0, v0, v55
    v_cvt_pk_bf16_f32 v107, v15, v0
    v_add_u32 v2, 122880, v4
    v_add_u32 v11, 122880, v5
    s_setprio 2
    s_waitcnt lgkmcnt(4)
    v_mfma_f32_32x32x16_bf16 v[184:199], v[28:31], v[64:67], 0
    ds_read_b64_tr_b16 v[24:25], v3 offset:16384
    ds_read_b64_tr_b16 v[26:27], v3 offset:17408
    s_add_u32 m0, s65, 0
    s_add_u32 s36, s50, s58
    buffer_load_dwordx4 v7, s[12:15], s36 offen  lds
    ds_write_b128 v8, v[88:91] offset:0
    v_mul_f32_e32 v13, v56, v56
    v_mul_f32_e32 v14, v57, v57
    v_fma_f32 v13, v13, s37, v9
    v_fma_f32 v14, v14, s37, v9
    v_mul_f32_e32 v13, v13, v56
    v_mul_f32_e32 v14, v14, v57
    v_mfma_f32_32x32x16_bf16 v[184:199], v[204:207], v[68:71], v[184:199]
    ds_read_b64_tr_b16 v[28:29], v3 offset:18432
    ds_read_b64_tr_b16 v[30:31], v3 offset:19456
    s_add_u32 m0, s65, 1024
    s_add_u32 s36, s51, s58
    buffer_load_dwordx4 v7, s[12:15], s36 offen  lds
    v_exp_f32_e32 v13, v13
    v_exp_f32_e32 v14, v14
    v_add_f32_e32 v13, 1.0, v13
    v_add_f32_e32 v14, 1.0, v14
    v_rcp_f32_e32 v13, v13
    v_rcp_f32_e32 v14, v14
    s_waitcnt lgkmcnt(5)
    v_mfma_f32_32x32x16_bf16 v[184:199], v[16:19], v[72:75], v[184:199]
    ds_read_b64_tr_b16 v[204:205], v12 offset:0
    ds_read_b64_tr_b16 v[206:207], v12 offset:1024
    s_add_u32 m0, s65, 2048
    s_add_u32 s36, s52, s58
    buffer_load_dwordx4 v7, s[12:15], s36 offen  lds
    ds_write_b128 v8, v[92:95] offset:1024
    v_mul_f32_e32 v13, v13, v56
    v_mul_f32_e32 v14, v14, v57
    v_cvt_pk_bf16_f32 v108, v13, v14
    v_mul_f32_e32 v15, v58, v58
    v_mul_f32_e32 v0, v59, v59
    v_fma_f32 v15, v15, s37, v9
    v_mfma_f32_32x32x16_bf16 v[184:199], v[20:23], v[76:79], v[184:199]
    ds_read_b64_tr_b16 v[16:17], v12 offset:2048
    ds_read_b64_tr_b16 v[18:19], v12 offset:3072
    v_fma_f32 v0, v0, s37, v9
    v_mul_f32_e32 v15, v15, v58
    v_mul_f32_e32 v0, v0, v59
    v_exp_f32_e32 v15, v15
    v_exp_f32_e32 v0, v0
    v_add_f32_e32 v15, 1.0, v15
    s_setprio 1
    s_waitcnt lgkmcnt(5)
    v_mfma_f32_32x32x16_bf16 v[184:199], v[24:27], v[80:83], v[184:199]
    ds_read_b64_tr_b16 v[20:21], v12 offset:8192
    ds_read_b64_tr_b16 v[22:23], v12 offset:9216
    ds_write_b128 v8, v[96:99] offset:2048
    v_add_f32_e32 v0, 1.0, v0
    v_rcp_f32_e32 v15, v15
    v_rcp_f32_e32 v0, v0
    v_mul_f32_e32 v15, v15, v58
    v_mul_f32_e32 v0, v0, v59
    v_cvt_pk_bf16_f32 v109, v15, v0
    v_mfma_f32_32x32x16_bf16 v[184:199], v[28:31], v[84:87], v[184:199]
    ds_read_b64_tr_b16 v[24:25], v12 offset:10240
    ds_read_b64_tr_b16 v[26:27], v12 offset:11264
    v_mul_f32_e32 v13, v60, v60
    v_mul_f32_e32 v14, v61, v61
    v_fma_f32 v13, v13, s37, v9
    v_fma_f32 v14, v14, s37, v9
    v_mul_f32_e32 v13, v13, v60
    v_mul_f32_e32 v14, v14, v61
    s_waitcnt lgkmcnt(5)
    v_mfma_f32_32x32x16_bf16 v[184:199], v[204:207], v[112:115], v[184:199]
    ds_read_b64_tr_b16 v[28:29], v12 offset:16384
    ds_read_b64_tr_b16 v[30:31], v12 offset:17408
    ds_write_b128 v8, v[100:103] offset:3072
    v_exp_f32_e32 v13, v13
    v_exp_f32_e32 v14, v14
    v_add_f32_e32 v13, 1.0, v13
    v_add_f32_e32 v14, 1.0, v14
    v_rcp_f32_e32 v13, v13
    v_rcp_f32_e32 v14, v14
    v_mfma_f32_32x32x16_bf16 v[184:199], v[16:19], v[116:119], v[184:199]
    ds_read_b64_tr_b16 v[204:205], v12 offset:18432
    ds_read_b64_tr_b16 v[206:207], v12 offset:19456
    v_mul_f32_e32 v13, v13, v60
    v_mul_f32_e32 v14, v14, v61
    v_cvt_pk_bf16_f32 v110, v13, v14
    v_mul_f32_e32 v15, v62, v62
    v_mul_f32_e32 v0, v63, v63
    v_fma_f32 v15, v15, s37, v9
    s_setprio 0
    s_waitcnt lgkmcnt(5)
    v_mfma_f32_32x32x16_bf16 v[184:199], v[20:23], v[120:123], v[184:199]
    ds_read_b64_tr_b16 v[16:17], v2 offset:0
    ds_read_b64_tr_b16 v[18:19], v2 offset:1024
    v_fma_f32 v0, v0, s37, v9
    v_mul_f32_e32 v15, v15, v62
    v_mul_f32_e32 v0, v0, v63
    v_exp_f32_e32 v15, v15
    v_exp_f32_e32 v0, v0
    v_add_f32_e32 v15, 1.0, v15
    v_mfma_f32_32x32x16_bf16 v[184:199], v[24:27], v[124:127], v[184:199]
    ds_read_b64_tr_b16 v[20:21], v2 offset:2048
    ds_read_b64_tr_b16 v[22:23], v2 offset:3072
    v_add_f32_e32 v0, 1.0, v0
    v_rcp_f32_e32 v15, v15
    v_rcp_f32_e32 v0, v0
    v_mul_f32_e32 v15, v15, v62
    v_mul_f32_e32 v0, v0, v63
    v_cvt_pk_bf16_f32 v111, v15, v0
    s_waitcnt lgkmcnt(4)
    v_mfma_f32_32x32x16_bf16 v[184:199], v[28:31], v[128:131], v[184:199]
    ds_read_b64_tr_b16 v[24:25], v2 offset:8192
    ds_read_b64_tr_b16 v[26:27], v2 offset:9216
    v_mfma_f32_32x32x16_bf16 v[184:199], v[204:207], v[132:135], v[184:199]
    ds_read_b64_tr_b16 v[28:29], v2 offset:10240
    ds_read_b64_tr_b16 v[30:31], v2 offset:11264
    ds_write_b128 v8, v[104:107] offset:4096
    ds_write_b128 v8, v[108:111] offset:5120
    s_waitcnt vmcnt(3)
    s_waitcnt lgkmcnt(0)
    s_barrier
    v_add_u32 v3, 73728, v4
    v_add_u32 v12, 73728, v5
    s_setprio 2
    v_mfma_f32_32x32x16_bf16 v[168:183], v[16:19], v[88:91], v[168:183]
    ds_read_b64_tr_b16 v[204:205], v2 offset:16384
    ds_read_b64_tr_b16 v[206:207], v2 offset:17408
    s_add_u32 m0, s65, 24576
    s_add_u32 s36, s53, s58
    buffer_load_dwordx4 v7, s[12:15], s36 offen  lds
    ds_read_b128 v[136:139], v6 offset:0
    v_mfma_f32_32x32x16_bf16 v[168:183], v[20:23], v[92:95], v[168:183]
    ds_read_b64_tr_b16 v[16:17], v2 offset:18432
    ds_read_b64_tr_b16 v[18:19], v2 offset:19456
    s_add_u32 m0, s65, 25600
    s_add_u32 s36, s54, s58
    buffer_load_dwordx4 v7, s[12:15], s36 offen  lds
    ds_read_b128 v[140:143], v6 offset:1024
    v_mfma_f32_32x32x16_bf16 v[168:183], v[24:27], v[96:99], v[168:183]
    ds_read_b64_tr_b16 v[20:21], v11 offset:0
    ds_read_b64_tr_b16 v[22:23], v11 offset:1024
    s_add_u32 m0, s65, 26624
    s_add_u32 s36, s55, s58
    buffer_load_dwordx4 v7, s[12:15], s36 offen  lds
    ds_read_b128 v[144:147], v6 offset:2048
    v_mfma_f32_32x32x16_bf16 v[168:183], v[28:31], v[100:103], v[168:183]
    ds_read_b64_tr_b16 v[24:25], v11 offset:2048
    ds_read_b64_tr_b16 v[26:27], v11 offset:3072
    ds_read_b128 v[148:151], v6 offset:3072
    s_setprio 1
    s_waitcnt lgkmcnt(7)
    v_mfma_f32_32x32x16_bf16 v[168:183], v[204:207], v[104:107], v[168:183]
    ds_read_b64_tr_b16 v[28:29], v11 offset:8192
    ds_read_b64_tr_b16 v[30:31], v11 offset:9216
    ds_read_b128 v[152:155], v6 offset:4096
    v_mfma_f32_32x32x16_bf16 v[168:183], v[16:19], v[108:111], v[168:183]
    ds_read_b64_tr_b16 v[204:205], v11 offset:10240
    ds_read_b64_tr_b16 v[206:207], v11 offset:11264
    ds_read_b128 v[156:159], v6 offset:5120
    s_waitcnt lgkmcnt(7)
    v_mfma_f32_32x32x16_bf16 v[168:183], v[20:23], v[136:139], v[168:183]
    ds_read_b64_tr_b16 v[16:17], v11 offset:16384
    ds_read_b64_tr_b16 v[18:19], v11 offset:17408
    v_mfma_f32_32x32x16_bf16 v[168:183], v[24:27], v[140:143], v[168:183]
    ds_read_b64_tr_b16 v[20:21], v11 offset:18432
    ds_read_b64_tr_b16 v[22:23], v11 offset:19456
    s_setprio 0
    s_waitcnt lgkmcnt(5)
    v_mfma_f32_32x32x16_bf16 v[168:183], v[28:31], v[144:147], v[168:183]
    ds_read_b64_tr_b16 v[24:25], v3 offset:0
    ds_read_b64_tr_b16 v[26:27], v3 offset:1024
Lffn_npoll:
    v_readfirstlane_b32 s66, v200
    s_cmp_lg_u32 s66, 0
    s_cbranch_scc1 Lffn_nok
    buffer_load_dword v200, v201, s[68:71], 0 offen offset:128 sc1
    s_waitcnt vmcnt(0)
    s_add_u32 s39, s39, 1
    s_cmp_lt_u32 s39, 0x40000
    s_cbranch_scc1 Lffn_npoll
Lffn_nok:
    v_lshlrev_b32 v201, 2, v1
    v_mfma_f32_32x32x16_bf16 v[168:183], v[204:207], v[148:151], v[168:183]
    ds_read_b64_tr_b16 v[28:29], v3 offset:2048
    ds_read_b64_tr_b16 v[30:31], v3 offset:3072
    s_waitcnt lgkmcnt(4)
    v_mfma_f32_32x32x16_bf16 v[168:183], v[16:19], v[152:155], v[168:183]
    s_waitcnt vmcnt(3)
    s_barrier
    ds_read_b64_tr_b16 v[204:205], v3 offset:8192
    ds_read_b64_tr_b16 v[206:207], v3 offset:9216
    v_mfma_f32_32x32x16_bf16 v[168:183], v[20:23], v[156:159], v[168:183]
    ds_read_b64_tr_b16 v[16:17], v3 offset:10240
    ds_read_b64_tr_b16 v[18:19], v3 offset:11264
    v_add_u32 v2, 0, v4
    v_add_u32 v11, 0, v5
    s_setprio 2
    s_waitcnt lgkmcnt(4)
    v_mfma_f32_32x32x16_bf16 v[184:199], v[24:27], v[88:91], v[184:199]
    ds_read_b64_tr_b16 v[20:21], v3 offset:16384
    ds_read_b64_tr_b16 v[22:23], v3 offset:17408
    s_add_u32 m0, s65, 122880
    s_add_u32 s36, s50, s59
    buffer_load_dwordx4 v7, s[12:15], s36 offen  lds
    s_add_u32 m0, s65, 123904
    s_add_u32 s36, s51, s59
    buffer_load_dwordx4 v7, s[12:15], s36 offen  lds
    v_mfma_f32_32x32x16_bf16 v[184:199], v[28:31], v[92:95], v[184:199]
    ds_read_b64_tr_b16 v[24:25], v3 offset:18432
    ds_read_b64_tr_b16 v[26:27], v3 offset:19456
    s_add_u32 m0, s65, 124928
    s_add_u32 s36, s52, s59
    buffer_load_dwordx4 v7, s[12:15], s36 offen  lds
    s_add_u32 m0, s65, 49152
    s_add_u32 s36, s53, s59
    buffer_load_dwordx4 v7, s[12:15], s36 offen  lds
    s_waitcnt lgkmcnt(4)
    v_mfma_f32_32x32x16_bf16 v[184:199], v[204:207], v[96:99], v[184:199]
    ds_read_b64_tr_b16 v[28:29], v12 offset:0
    ds_read_b64_tr_b16 v[30:31], v12 offset:1024
    s_add_u32 m0, s65, 50176
    s_add_u32 s36, s54, s59
    buffer_load_dwordx4 v7, s[12:15], s36 offen  lds
    v_mfma_f32_32x32x16_bf16 v[184:199], v[16:19], v[100:103], v[184:199]
    ds_read_b64_tr_b16 v[204:205], v12 offset:2048
    ds_read_b64_tr_b16 v[206:207], v12 offset:3072
    s_add_u32 m0, s65, 51200
    s_add_u32 s36, s55, s59
    buffer_load_dwordx4 v7, s[12:15], s36 offen  lds
    v_cvt_pk_bf16_f32 v160, v168, v169
    s_setprio 1
    s_waitcnt lgkmcnt(4)
    v_mfma_f32_32x32x16_bf16 v[184:199], v[20:23], v[104:107], v[184:199]
    ds_read_b64_tr_b16 v[16:17], v12 offset:8192
    ds_read_b64_tr_b16 v[18:19], v12 offset:9216
    s_add_u32 m0, s65, 98304
    s_add_u32 s36, s50, s60
    buffer_load_dwordx4 v7, s[12:15], s36 offen  lds
    v_cvt_pk_bf16_f32 v161, v170, v171
    v_mfma_f32_32x32x16_bf16 v[184:199], v[24:27], v[108:111], v[184:199]
    ds_read_b64_tr_b16 v[20:21], v12 offset:10240
    ds_read_b64_tr_b16 v[22:23], v12 offset:11264
    s_add_u32 m0, s65, 99328
    s_add_u32 s36, s51, s60
    buffer_load_dwordx4 v7, s[12:15], s36 offen  lds
    v_cvt_pk_bf16_f32 v162, v172, v173
    s_waitcnt lgkmcnt(4)
    v_mfma_f32_32x32x16_bf16 v[184:199], v[28:31], v[136:139], v[184:199]
    ds_read_b64_tr_b16 v[24:25], v12 offset:16384
    ds_read_b64_tr_b16 v[26:27], v12 offset:17408
    s_add_u32 m0, s65, 100352
    s_add_u32 s36, s52, s60
    buffer_load_dwordx4 v7, s[12:15], s36 offen  lds
    v_cvt_pk_bf16_f32 v163, v174, v175
    s_mul_i32 s36, s56, 384
    s_add_u32 s36, s36, s38
    buffer_store_dwordx4 v[160:163], v10, s[20:23], s36 offen offset:0 sc1
    v_mfma_f32_32x32x16_bf16 v[184:199], v[204:207], v[140:143], v[184:199]
    ds_read_b64_tr_b16 v[28:29], v12 offset:18432
    ds_read_b64_tr_b16 v[30:31], v12 offset:19456
    v_cvt_pk_bf16_f32 v164, v176, v177
    s_setprio 0
    s_waitcnt lgkmcnt(4)
    v_mfma_f32_32x32x16_bf16 v[184:199], v[16:19], v[144:147], v[184:199]
    ds_read_b64_tr_b16 v[204:205], v2 offset:0
    ds_read_b64_tr_b16 v[206:207], v2 offset:1024
    v_cvt_pk_bf16_f32 v165, v178, v179
    v_mfma_f32_32x32x16_bf16 v[184:199], v[20:23], v[148:151], v[184:199]
    ds_read_b64_tr_b16 v[16:17], v2 offset:2048
    ds_read_b64_tr_b16 v[18:19], v2 offset:3072
    v_cvt_pk_bf16_f32 v166, v180, v181
    s_waitcnt lgkmcnt(4)
    v_mfma_f32_32x32x16_bf16 v[184:199], v[24:27], v[152:155], v[184:199]
    s_waitcnt vmcnt(10)
    s_barrier
    ds_read_b64_tr_b16 v[20:21], v2 offset:8192
    ds_read_b64_tr_b16 v[22:23], v2 offset:9216
    v_cvt_pk_bf16_f32 v167, v182, v183
    s_mul_i32 s36, s56, 384
    s_add_u32 s36, s36, s38
    buffer_store_dwordx4 v[164:167], v10, s[20:23], s36 offen offset:1024 sc1
    v_mfma_f32_32x32x16_bf16 v[184:199], v[28:31], v[156:159], v[184:199]
    ds_read_b64_tr_b16 v[24:25], v2 offset:10240
    ds_read_b64_tr_b16 v[26:27], v2 offset:11264
    v_add_u32 v3, 24576, v4
    v_add_u32 v12, 24576, v5
    s_setprio 2
    s_waitcnt lgkmcnt(4)
    v_mfma_f32_32x32x16_bf16 v[168:183], v[204:207], v[64:67], 0
    ds_read_b64_tr_b16 v[28:29], v2 offset:16384
    ds_read_b64_tr_b16 v[30:31], v2 offset:17408
    s_add_u32 m0, s65, 73728
    s_add_u32 s36, s53, s60
    buffer_load_dwordx4 v7, s[12:15], s36 offen  lds
    v_mfma_f32_32x32x16_bf16 v[168:183], v[16:19], v[68:71], v[168:183]
    ds_read_b64_tr_b16 v[204:205], v2 offset:18432
    ds_read_b64_tr_b16 v[206:207], v2 offset:19456
    s_add_u32 m0, s65, 74752
    s_add_u32 s36, s54, s60
    buffer_load_dwordx4 v7, s[12:15], s36 offen  lds
    s_waitcnt lgkmcnt(4)
    v_mfma_f32_32x32x16_bf16 v[168:183], v[20:23], v[72:75], v[168:183]
    ds_read_b64_tr_b16 v[16:17], v11 offset:0
    ds_read_b64_tr_b16 v[18:19], v11 offset:1024
    s_add_u32 m0, s65, 75776
    s_add_u32 s36, s55, s60
    buffer_load_dwordx4 v7, s[12:15], s36 offen  lds
    v_mfma_f32_32x32x16_bf16 v[168:183], v[24:27], v[76:79], v[168:183]
    ds_read_b64_tr_b16 v[20:21], v11 offset:2048
    ds_read_b64_tr_b16 v[22:23], v11 offset:3072
    v_cvt_pk_bf16_f32 v160, v184, v185
    s_setprio 1
    s_waitcnt lgkmcnt(4)
    v_mfma_f32_32x32x16_bf16 v[168:183], v[28:31], v[80:83], v[168:183]
    ds_read_b64_tr_b16 v[24:25], v11 offset:8192
    ds_read_b64_tr_b16 v[26:27], v11 offset:9216
    v_cvt_pk_bf16_f32 v161, v186, v187
    v_mfma_f32_32x32x16_bf16 v[168:183], v[204:207], v[84:87], v[168:183]
    ds_read_b64_tr_b16 v[28:29], v11 offset:10240
    ds_read_b64_tr_b16 v[30:31], v11 offset:11264
    v_cvt_pk_bf16_f32 v162, v188, v189
    s_waitcnt lgkmcnt(4)
    v_mfma_f32_32x32x16_bf16 v[168:183], v[16:19], v[112:115], v[168:183]
    ds_read_b64_tr_b16 v[204:205], v11 offset:16384
    ds_read_b64_tr_b16 v[206:207], v11 offset:17408
    v_cvt_pk_bf16_f32 v163, v190, v191
    s_mul_i32 s36, s57, 384
    s_add_u32 s36, s36, s38
    buffer_store_dwordx4 v[160:163], v10, s[20:23], s36 offen offset:0 sc1
    v_mfma_f32_32x32x16_bf16 v[168:183], v[20:23], v[116:119], v[168:183]
    ds_read_b64_tr_b16 v[16:17], v11 offset:18432
    ds_read_b64_tr_b16 v[18:19], v11 offset:19456
    v_cvt_pk_bf16_f32 v164, v192, v193
    s_setprio 0
    s_waitcnt lgkmcnt(4)
    v_mfma_f32_32x32x16_bf16 v[168:183], v[24:27], v[120:123], v[168:183]
    ds_read_b64_tr_b16 v[20:21], v3 offset:0
    ds_read_b64_tr_b16 v[22:23], v3 offset:1024
    v_cvt_pk_bf16_f32 v165, v194, v195
    v_mfma_f32_32x32x16_bf16 v[168:183], v[28:31], v[124:127], v[168:183]
    ds_read_b64_tr_b16 v[24:25], v3 offset:2048
    ds_read_b64_tr_b16 v[26:27], v3 offset:3072
    v_cvt_pk_bf16_f32 v166, v196, v197
    s_waitcnt lgkmcnt(4)
    v_mfma_f32_32x32x16_bf16 v[168:183], v[204:207], v[128:131], v[168:183]
    s_waitcnt vmcnt(12)
    s_barrier
    ds_read_b64_tr_b16 v[28:29], v3 offset:8192
    ds_read_b64_tr_b16 v[30:31], v3 offset:9216
    v_cvt_pk_bf16_f32 v167, v198, v199
    s_mul_i32 s36, s57, 384
    s_add_u32 s36, s36, s38
    buffer_store_dwordx4 v[164:167], v10, s[20:23], s36 offen offset:1024 sc1
    v_mfma_f32_32x32x16_bf16 v[168:183], v[16:19], v[132:135], v[168:183]
    ds_read_b64_tr_b16 v[204:205], v3 offset:10240
    ds_read_b64_tr_b16 v[206:207], v3 offset:11264
    v_add_u32 v2, 122880, v4
    v_add_u32 v11, 122880, v5
    s_setprio 2
    s_waitcnt lgkmcnt(4)
    v_mfma_f32_32x32x16_bf16 v[168:183], v[20:23], v[88:91], v[168:183]
    ds_read_b64_tr_b16 v[16:17], v3 offset:16384
    ds_read_b64_tr_b16 v[18:19], v3 offset:17408
    s_add_u32 m0, s65, 0
    s_add_u32 s36, s50, s61
    buffer_load_dwordx4 v7, s[12:15], s36 offen  lds
    v_mfma_f32_32x32x16_bf16 v[168:183], v[24:27], v[92:95], v[168:183]
    ds_read_b64_tr_b16 v[20:21], v3 offset:18432
    ds_read_b64_tr_b16 v[22:23], v3 offset:19456
    s_add_u32 m0, s65, 1024
    s_add_u32 s36, s51, s61
    buffer_load_dwordx4 v7, s[12:15], s36 offen  lds
    s_waitcnt lgkmcnt(4)
    v_mfma_f32_32x32x16_bf16 v[168:183], v[28:31], v[96:99], v[168:183]
    ds_read_b64_tr_b16 v[24:25], v12 offset:0
    ds_read_b64_tr_b16 v[26:27], v12 offset:1024
    s_add_u32 m0, s65, 2048
    s_add_u32 s36, s52, s61
    buffer_load_dwordx4 v7, s[12:15], s36 offen  lds
    v_mfma_f32_32x32x16_bf16 v[168:183], v[204:207], v[100:103], v[168:183]
    ds_read_b64_tr_b16 v[28:29], v12 offset:2048
    ds_read_b64_tr_b16 v[30:31], v12 offset:3072
    s_setprio 1
    s_waitcnt lgkmcnt(4)
    v_mfma_f32_32x32x16_bf16 v[168:183], v[16:19], v[104:107], v[168:183]
    ds_read_b64_tr_b16 v[204:205], v12 offset:8192
    ds_read_b64_tr_b16 v[206:207], v12 offset:9216
    v_mfma_f32_32x32x16_bf16 v[168:183], v[20:23], v[108:111], v[168:183]
    ds_read_b64_tr_b16 v[16:17], v12 offset:10240
    ds_read_b64_tr_b16 v[18:19], v12 offset:11264
    s_waitcnt lgkmcnt(4)
    v_mfma_f32_32x32x16_bf16 v[168:183], v[24:27], v[136:139], v[168:183]
    ds_read_b64_tr_b16 v[20:21], v12 offset:16384
    ds_read_b64_tr_b16 v[22:23], v12 offset:17408
    v_mfma_f32_32x32x16_bf16 v[168:183], v[28:31], v[140:143], v[168:183]
    ds_read_b64_tr_b16 v[24:25], v12 offset:18432
    ds_read_b64_tr_b16 v[26:27], v12 offset:19456
    s_setprio 0
    s_waitcnt lgkmcnt(4)
    v_mfma_f32_32x32x16_bf16 v[168:183], v[204:207], v[144:147], v[168:183]
    ds_read_b64_tr_b16 v[28:29], v2 offset:0
    ds_read_b64_tr_b16 v[30:31], v2 offset:1024
    v_mfma_f32_32x32x16_bf16 v[168:183], v[16:19], v[148:151], v[168:183]
    ds_read_b64_tr_b16 v[204:205], v2 offset:2048
    ds_read_b64_tr_b16 v[206:207], v2 offset:3072
    s_waitcnt lgkmcnt(4)
    v_mfma_f32_32x32x16_bf16 v[168:183], v[20:23], v[152:155], v[168:183]
    s_waitcnt vmcnt(13)
    s_barrier
    ds_read_b64_tr_b16 v[16:17], v2 offset:8192
    ds_read_b64_tr_b16 v[18:19], v2 offset:9216
    v_mfma_f32_32x32x16_bf16 v[168:183], v[24:27], v[156:159], v[168:183]
    ds_read_b64_tr_b16 v[20:21], v2 offset:10240
    ds_read_b64_tr_b16 v[22:23], v2 offset:11264
    v_add_u32 v3, 49152, v4
    v_add_u32 v12, 49152, v5
    s_setprio 2
    s_waitcnt lgkmcnt(4)
    v_mfma_f32_32x32x16_bf16 v[184:199], v[28:31], v[64:67], 0
    ds_read_b64_tr_b16 v[24:25], v2 offset:16384
    ds_read_b64_tr_b16 v[26:27], v2 offset:17408
    s_add_u32 m0, s65, 24576
    s_add_u32 s36, s53, s61
    buffer_load_dwordx4 v7, s[12:15], s36 offen  lds
    v_mfma_f32_32x32x16_bf16 v[184:199], v[204:207], v[68:71], v[184:199]
    ds_read_b64_tr_b16 v[28:29], v2 offset:18432
    ds_read_b64_tr_b16 v[30:31], v2 offset:19456
    s_add_u32 m0, s65, 25600
    s_add_u32 s36, s54, s61
    buffer_load_dwordx4 v7, s[12:15], s36 offen  lds
    s_waitcnt lgkmcnt(4)
    v_mfma_f32_32x32x16_bf16 v[184:199], v[16:19], v[72:75], v[184:199]
    ds_read_b64_tr_b16 v[204:205], v11 offset:0
    ds_read_b64_tr_b16 v[206:207], v11 offset:1024
    s_add_u32 m0, s65, 26624
    s_add_u32 s36, s55, s61
    buffer_load_dwordx4 v7, s[12:15], s36 offen  lds
    v_mfma_f32_32x32x16_bf16 v[184:199], v[20:23], v[76:79], v[184:199]
    ds_read_b64_tr_b16 v[16:17], v11 offset:2048
    ds_read_b64_tr_b16 v[18:19], v11 offset:3072
    v_cvt_pk_bf16_f32 v160, v168, v169
    s_setprio 1
    s_waitcnt lgkmcnt(4)
    v_mfma_f32_32x32x16_bf16 v[184:199], v[24:27], v[80:83], v[184:199]
    ds_read_b64_tr_b16 v[20:21], v11 offset:8192
    ds_read_b64_tr_b16 v[22:23], v11 offset:9216
    v_cvt_pk_bf16_f32 v161, v170, v171
    v_mfma_f32_32x32x16_bf16 v[184:199], v[28:31], v[84:87], v[184:199]
    ds_read_b64_tr_b16 v[24:25], v11 offset:10240
    ds_read_b64_tr_b16 v[26:27], v11 offset:11264
    v_cvt_pk_bf16_f32 v162, v172, v173
    s_waitcnt lgkmcnt(4)
    v_mfma_f32_32x32x16_bf16 v[184:199], v[204:207], v[112:115], v[184:199]
    ds_read_b64_tr_b16 v[28:29], v11 offset:16384
    ds_read_b64_tr_b16 v[30:31], v11 offset:17408
    v_cvt_pk_bf16_f32 v163, v174, v175
    s_mul_i32 s36, s58, 384
    s_add_u32 s36, s36, s38
    buffer_store_dwordx4 v[160:163], v10, s[20:23], s36 offen offset:0 sc1
    v_mfma_f32_32x32x16_bf16 v[184:199], v[16:19], v[116:119], v[184:199]
    ds_read_b64_tr_b16 v[204:205], v11 offset:18432
    ds_read_b64_tr_b16 v[206:207], v11 offset:19456
    v_cvt_pk_bf16_f32 v164, v176, v177
    s_setprio 0
    s_waitcnt lgkmcnt(4)
    v_mfma_f32_32x32x16_bf16 v[184:199], v[20:23], v[120:123], v[184:199]
    ds_read_b64_tr_b16 v[16:17], v3 offset:0
    ds_read_b64_tr_b16 v[18:19], v3 offset:1024
    v_cvt_pk_bf16_f32 v165, v178, v179
    v_mfma_f32_32x32x16_bf16 v[184:199], v[24:27], v[124:127], v[184:199]
    ds_read_b64_tr_b16 v[20:21], v3 offset:2048
    ds_read_b64_tr_b16 v[22:23], v3 offset:3072
    v_cvt_pk_bf16_f32 v166, v180, v181
    s_waitcnt lgkmcnt(4)
    v_mfma_f32_32x32x16_bf16 v[184:199], v[28:31], v[128:131], v[184:199]
    s_waitcnt vmcnt(14)
    s_waitcnt vmcnt(12)
    s_barrier
    ds_read_b64_tr_b16 v[24:25], v3 offset:8192
    ds_read_b64_tr_b16 v[26:27], v3 offset:9216
    v_cvt_pk_bf16_f32 v167, v182, v183
    s_mul_i32 s36, s58, 384
    s_add_u32 s36, s36, s38
    buffer_store_dwordx4 v[164:167], v10, s[20:23], s36 offen offset:1024 sc1
    v_mfma_f32_32x32x16_bf16 v[184:199], v[204:207], v[132:135], v[184:199]
    ds_read_b64_tr_b16 v[28:29], v3 offset:10240
    ds_read_b64_tr_b16 v[30:31], v3 offset:11264
    v_add_u32 v2, 98304, v4
    v_add_u32 v11, 98304, v5
    s_setprio 2
    s_waitcnt lgkmcnt(4)
    v_mfma_f32_32x32x16_bf16 v[184:199], v[16:19], v[88:91], v[184:199]
    ds_read_b64_tr_b16 v[204:205], v3 offset:16384
    ds_read_b64_tr_b16 v[206:207], v3 offset:17408
    s_add_u32 m0, s65, 122880
    s_add_u32 s36, s50, s62
    buffer_load_dwordx4 v7, s[12:15], s36 offen  lds
    v_mfma_f32_32x32x16_bf16 v[184:199], v[20:23], v[92:95], v[184:199]
    ds_read_b64_tr_b16 v[16:17], v3 offset:18432
    ds_read_b64_tr_b16 v[18:19], v3 offset:19456
    s_add_u32 m0, s65, 123904
    s_add_u32 s36, s51, s62
    buffer_load_dwordx4 v7, s[12:15], s36 offen  lds
    s_mul_i32 s36, s56, 24
    s_add_u32 s36, s36, s67
    buffer_store_dword v200, v201, s[20:23], s36 offen sc1
    s_waitcnt lgkmcnt(4)
    v_mfma_f32_32x32x16_bf16 v[184:199], v[24:27], v[96:99], v[184:199]
    ds_read_b64_tr_b16 v[20:21], v12 offset:0
    ds_read_b64_tr_b16 v[22:23], v12 offset:1024
    s_add_u32 m0, s65, 124928
    s_add_u32 s36, s52, s62
    buffer_load_dwordx4 v7, s[12:15], s36 offen  lds
    v_mfma_f32_32x32x16_bf16 v[184:199], v[28:31], v[100:103], v[184:199]
    ds_read_b64_tr_b16 v[24:25], v12 offset:2048
    ds_read_b64_tr_b16 v[26:27], v12 offset:3072
    s_setprio 1
    s_waitcnt lgkmcnt(4)
    v_mfma_f32_32x32x16_bf16 v[184:199], v[204:207], v[104:107], v[184:199]
    ds_read_b64_tr_b16 v[28:29], v12 offset:8192
    ds_read_b64_tr_b16 v[30:31], v12 offset:9216
    v_mfma_f32_32x32x16_bf16 v[184:199], v[16:19], v[108:111], v[184:199]
    ds_read_b64_tr_b16 v[204:205], v12 offset:10240
    ds_read_b64_tr_b16 v[206:207], v12 offset:11264
    s_waitcnt lgkmcnt(4)
    v_mfma_f32_32x32x16_bf16 v[184:199], v[20:23], v[136:139], v[184:199]
    ds_read_b64_tr_b16 v[16:17], v12 offset:16384
    ds_read_b64_tr_b16 v[18:19], v12 offset:17408
    v_mfma_f32_32x32x16_bf16 v[184:199], v[24:27], v[140:143], v[184:199]
    ds_read_b64_tr_b16 v[20:21], v12 offset:18432
    ds_read_b64_tr_b16 v[22:23], v12 offset:19456
    s_setprio 0
    s_waitcnt lgkmcnt(4)
    v_mfma_f32_32x32x16_bf16 v[184:199], v[28:31], v[144:147], v[184:199]
    ds_read_b64_tr_b16 v[24:25], v2 offset:0
    ds_read_b64_tr_b16 v[26:27], v2 offset:1024
    v_mfma_f32_32x32x16_bf16 v[184:199], v[204:207], v[148:151], v[184:199]
    ds_read_b64_tr_b16 v[28:29], v2 offset:2048
    ds_read_b64_tr_b16 v[30:31], v2 offset:3072
    s_waitcnt lgkmcnt(4)
    v_mfma_f32_32x32x16_bf16 v[184:199], v[16:19], v[152:155], v[184:199]
    s_waitcnt vmcnt(14)
    s_waitcnt vmcnt(12)
    s_barrier
    ds_read_b64_tr_b16 v[204:205], v2 offset:8192
    ds_read_b64_tr_b16 v[206:207], v2 offset:9216
    v_mfma_f32_32x32x16_bf16 v[184:199], v[20:23], v[156:159], v[184:199]
    ds_read_b64_tr_b16 v[16:17], v2 offset:10240
    ds_read_b64_tr_b16 v[18:19], v2 offset:11264
    v_add_u32 v3, 73728, v4
    v_add_u32 v12, 73728, v5
    s_setprio 2
    s_waitcnt lgkmcnt(4)
    v_mfma_f32_32x32x16_bf16 v[168:183], v[24:27], v[64:67], 0
    ds_read_b64_tr_b16 v[20:21], v2 offset:16384
    ds_read_b64_tr_b16 v[22:23], v2 offset:17408
    s_add_u32 m0, s65, 49152
    s_add_u32 s36, s53, s62
    buffer_load_dwordx4 v7, s[12:15], s36 offen  lds
    v_mfma_f32_32x32x16_bf16 v[168:183], v[28:31], v[68:71], v[168:183]
    ds_read_b64_tr_b16 v[24:25], v2 offset:18432
    ds_read_b64_tr_b16 v[26:27], v2 offset:19456
    s_add_u32 m0, s65, 50176
    s_add_u32 s36, s54, s62
    buffer_load_dwordx4 v7, s[12:15], s36 offen  lds
    s_mul_i32 s36, s57, 24
    s_add_u32 s36, s36, s67
    buffer_store_dword v200, v201, s[20:23], s36 offen sc1
    s_waitcnt lgkmcnt(4)
    v_mfma_f32_32x32x16_bf16 v[168:183], v[204:207], v[72:75], v[168:183]
    ds_read_b64_tr_b16 v[28:29], v11 offset:0
    ds_read_b64_tr_b16 v[30:31], v11 offset:1024
    s_add_u32 m0, s65, 51200
    s_add_u32 s36, s55, s62
    buffer_load_dwordx4 v7, s[12:15], s36 offen  lds
    v_mfma_f32_32x32x16_bf16 v[168:183], v[16:19], v[76:79], v[168:183]
    ds_read_b64_tr_b16 v[204:205], v11 offset:2048
    ds_read_b64_tr_b16 v[206:207], v11 offset:3072
    v_cvt_pk_bf16_f32 v160, v184, v185
    s_setprio 1
    s_waitcnt lgkmcnt(4)
    v_mfma_f32_32x32x16_bf16 v[168:183], v[20:23], v[80:83], v[168:183]
    ds_read_b64_tr_b16 v[16:17], v11 offset:8192
    ds_read_b64_tr_b16 v[18:19], v11 offset:9216
    v_cvt_pk_bf16_f32 v161, v186, v187
    v_mfma_f32_32x32x16_bf16 v[168:183], v[24:27], v[84:87], v[168:183]
    ds_read_b64_tr_b16 v[20:21], v11 offset:10240
    ds_read_b64_tr_b16 v[22:23], v11 offset:11264
    v_cvt_pk_bf16_f32 v162, v188, v189
    s_waitcnt lgkmcnt(4)
    v_mfma_f32_32x32x16_bf16 v[168:183], v[28:31], v[112:115], v[168:183]
    ds_read_b64_tr_b16 v[24:25], v11 offset:16384
    ds_read_b64_tr_b16 v[26:27], v11 offset:17408
    v_cvt_pk_bf16_f32 v163, v190, v191
    s_mul_i32 s36, s59, 384
    s_add_u32 s36, s36, s38
    buffer_store_dwordx4 v[160:163], v10, s[20:23], s36 offen offset:0 sc1
    v_mfma_f32_32x32x16_bf16 v[168:183], v[204:207], v[116:119], v[168:183]
    ds_read_b64_tr_b16 v[28:29], v11 offset:18432
    ds_read_b64_tr_b16 v[30:31], v11 offset:19456
    v_cvt_pk_bf16_f32 v164, v192, v193
    s_setprio 0
    s_waitcnt lgkmcnt(4)
    v_mfma_f32_32x32x16_bf16 v[168:183], v[16:19], v[120:123], v[168:183]
    ds_read_b64_tr_b16 v[204:205], v3 offset:0
    ds_read_b64_tr_b16 v[206:207], v3 offset:1024
    v_cvt_pk_bf16_f32 v165, v194, v195
    v_mfma_f32_32x32x16_bf16 v[168:183], v[20:23], v[124:127], v[168:183]
    ds_read_b64_tr_b16 v[16:17], v3 offset:2048
    ds_read_b64_tr_b16 v[18:19], v3 offset:3072
    v_cvt_pk_bf16_f32 v166, v196, v197
    s_waitcnt lgkmcnt(4)
    v_mfma_f32_32x32x16_bf16 v[168:183], v[24:27], v[128:131], v[168:183]
    s_waitcnt vmcnt(14)
    s_barrier
    ds_read_b64_tr_b16 v[20:21], v3 offset:8192
    ds_read_b64_tr_b16 v[22:23], v3 offset:9216
    v_cvt_pk_bf16_f32 v167, v198, v199
    s_mul_i32 s36, s59, 384
    s_add_u32 s36, s36, s38
    buffer_store_dwordx4 v[164:167], v10, s[20:23], s36 offen offset:1024 sc1
    v_mfma_f32_32x32x16_bf16 v[168:183], v[28:31], v[132:135], v[168:183]
    ds_read_b64_tr_b16 v[24:25], v3 offset:10240
    ds_read_b64_tr_b16 v[26:27], v3 offset:11264
    v_add_u32 v2, 0, v4
    v_add_u32 v11, 0, v5
    s_setprio 2
    s_waitcnt lgkmcnt(4)
    v_mfma_f32_32x32x16_bf16 v[168:183], v[204:207], v[88:91], v[168:183]
    ds_read_b64_tr_b16 v[28:29], v3 offset:16384
    ds_read_b64_tr_b16 v[30:31], v3 offset:17408
    s_add_u32 m0, s65, 98304
    s_add_u32 s36, s50, s63
    buffer_load_dwordx4 v7, s[12:15], s36 offen  lds
    s_mov_b32 s8, s4
    s_and_b32 s9, s5, 0xffff
    s_mov_b32 s10, 2359296
    v_mfma_f32_32x32x16_bf16 v[168:183], v[16:19], v[92:95], v[168:183]
    ds_read_b64_tr_b16 v[204:205], v3 offset:18432
    ds_read_b64_tr_b16 v[206:207], v3 offset:19456
    s_add_u32 m0, s65, 99328
    s_add_u32 s36, s51, s63
    buffer_load_dwordx4 v7, s[12:15], s36 offen  lds
    s_mov_b32 s11, 0x00020000
    s_mov_b32 s24, s6
    s_and_b32 s25, s7, 0xffff
    s_mov_b32 s26, 1152
    s_waitcnt lgkmcnt(4)
    v_mfma_f32_32x32x16_bf16 v[168:183], v[20:23], v[96:99], v[168:183]
    ds_read_b64_tr_b16 v[16:17], v12 offset:0
    ds_read_b64_tr_b16 v[18:19], v12 offset:1024
    s_add_u32 m0, s65, 100352
    s_add_u32 s36, s52, s63
    buffer_load_dwordx4 v7, s[12:15], s36 offen  lds
    s_mov_b32 s27, 0x00020000
    s_mul_i32 s40, s28, 12
    s_add_u32 s40, s40, s31
    s_lshr_b32 s41, s40, 3
    v_mfma_f32_32x32x16_bf16 v[168:183], v[24:27], v[100:103], v[168:183]
    ds_read_b64_tr_b16 v[20:21], v12 offset:2048
    ds_read_b64_tr_b16 v[22:23], v12 offset:3072
    s_add_u32 s41, s41, 4
    s_and_b32 s42, s32, 7
    s_add_u32 s41, s41, s42
    s_sub_u32 s42, s41, 9
    s_setprio 1
    s_waitcnt lgkmcnt(4)
    v_mfma_f32_32x32x16_bf16 v[168:183], v[28:31], v[104:107], v[168:183]
    ds_read_b64_tr_b16 v[24:25], v12 offset:8192
    ds_read_b64_tr_b16 v[26:27], v12 offset:9216
    s_min_u32 s41, s41, s42
    s_sub_u32 s42, s41, 9
    s_min_u32 s41, s41, s42
    s_lshl_b32 s41, s41, 1
    v_mfma_f32_32x32x16_bf16 v[168:183], v[204:207], v[108:111], v[168:183]
    ds_read_b64_tr_b16 v[28:29], v12 offset:10240
    ds_read_b64_tr_b16 v[30:31], v12 offset:11264
    s_and_b32 s42, s40, 1
    s_add_u32 s44, s41, s42
    s_lshr_b32 s47, s40, 1
    s_waitcnt lgkmcnt(4)
    v_mfma_f32_32x32x16_bf16 v[168:183], v[16:19], v[136:139], v[168:183]
    ds_read_b64_tr_b16 v[204:205], v12 offset:16384
    ds_read_b64_tr_b16 v[206:207], v12 offset:17408
    s_and_b32 s47, s47, 3
    s_lshl_b32 s41, s32, 2
    s_add_u32 s41, s41, s47
    s_mul_i32 s46, s41, 36864
    v_mfma_f32_32x32x16_bf16 v[168:183], v[20:23], v[140:143], v[168:183]
    ds_read_b64_tr_b16 v[16:17], v12 offset:18432
    ds_read_b64_tr_b16 v[18:19], v12 offset:19456
    s_lshl_b32 s42, s44, 6
    s_add_u32 s46, s46, s42
    s_mul_i32 s45, s41, 18
    s_add_u32 s45, s45, s44
    s_setprio 0
    s_waitcnt lgkmcnt(4)
    v_mfma_f32_32x32x16_bf16 v[168:183], v[24:27], v[144:147], v[168:183]
    ds_read_b64_tr_b16 v[20:21], v2 offset:0
    ds_read_b64_tr_b16 v[22:23], v2 offset:1024
    s_mul_i32 s45, s45, 24576
    s_add_u32 s45, s45, 0
    s_lshl_b32 s49, s44, 17
    s_lshl_b32 s43, s41, 6
    v_mfma_f32_32x32x16_bf16 v[168:183], v[28:31], v[148:151], v[168:183]
    ds_read_b64_tr_b16 v[24:25], v2 offset:2048
    ds_read_b64_tr_b16 v[26:27], v2 offset:3072
    s_add_u32 s49, s49, s43
    s_add_u32 s49, s49, 30670848
    s_lshl_b32 s43, s41, 7
    s_add_u32 s43, s43, 33030144
    s_waitcnt lgkmcnt(4)
    v_mfma_f32_32x32x16_bf16 v[168:183], v[204:207], v[152:155], v[168:183]
    s_waitcnt vmcnt(15)
    s_waitcnt vmcnt(13)
    s_barrier
    ds_read_b64_tr_b16 v[28:29], v2 offset:8192
    ds_read_b64_tr_b16 v[30:31], v2 offset:9216
    s_cmp_lt_u32 s40, 40
    s_cselect_b32 s46, s46, 1879048192
    s_cselect_b32 s49, s49, 1879048192
    s_cselect_b32 s43, s43, 1879048192
    s_cselect_b32 s42, s42, 1879048192
    s_lshl_b32 s48, s28, 11
    s_add_u32 s48, s48, 147456
    s_mov_b32 s33, s43
    s_mov_b32 s34, s42
    v_mfma_f32_32x32x16_bf16 v[168:183], v[16:19], v[156:159], v[168:183]
    ds_read_b64_tr_b16 v[204:205], v2 offset:10240
    ds_read_b64_tr_b16 v[206:207], v2 offset:11264
    v_add_u32 v3, 24576, v4
    v_add_u32 v12, 24576, v5
    s_setprio 2
    s_waitcnt lgkmcnt(4)
    v_mfma_f32_32x32x16_bf16 v[184:199], v[20:23], v[64:67], 0
    ds_read_b64_tr_b16 v[16:17], v2 offset:16384
    ds_read_b64_tr_b16 v[18:19], v2 offset:17408
    s_add_u32 m0, s65, 73728
    s_add_u32 s36, s53, s63
    buffer_load_dwordx4 v7, s[12:15], s36 offen  lds
    v_mfma_f32_32x32x16_bf16 v[184:199], v[24:27], v[68:71], v[184:199]
    ds_read_b64_tr_b16 v[20:21], v2 offset:18432
    ds_read_b64_tr_b16 v[22:23], v2 offset:19456
    s_add_u32 m0, s65, 74752
    s_add_u32 s36, s54, s63
    buffer_load_dwordx4 v7, s[12:15], s36 offen  lds
    s_mul_i32 s36, s58, 24
    s_add_u32 s36, s36, s67
    buffer_store_dword v200, v201, s[20:23], s36 offen sc1
    s_waitcnt lgkmcnt(4)
    v_mfma_f32_32x32x16_bf16 v[184:199], v[28:31], v[72:75], v[184:199]
    ds_read_b64_tr_b16 v[24:25], v11 offset:0
    ds_read_b64_tr_b16 v[26:27], v11 offset:1024
    s_add_u32 m0, s65, 75776
    s_add_u32 s36, s55, s63
    buffer_load_dwordx4 v7, s[12:15], s36 offen  lds
    v_mfma_f32_32x32x16_bf16 v[184:199], v[204:207], v[76:79], v[184:199]
    ds_read_b64_tr_b16 v[28:29], v11 offset:2048
    ds_read_b64_tr_b16 v[30:31], v11 offset:3072
    v_cvt_pk_bf16_f32 v160, v168, v169
    s_setprio 1
    s_waitcnt lgkmcnt(4)
    v_mfma_f32_32x32x16_bf16 v[184:199], v[16:19], v[80:83], v[184:199]
    ds_read_b64_tr_b16 v[204:205], v11 offset:8192
    ds_read_b64_tr_b16 v[206:207], v11 offset:9216
    v_cvt_pk_bf16_f32 v161, v170, v171
    v_mfma_f32_32x32x16_bf16 v[184:199], v[20:23], v[84:87], v[184:199]
    ds_read_b64_tr_b16 v[16:17], v11 offset:10240
    ds_read_b64_tr_b16 v[18:19], v11 offset:11264
    v_cvt_pk_bf16_f32 v162, v172, v173
    s_waitcnt lgkmcnt(4)
    v_mfma_f32_32x32x16_bf16 v[184:199], v[24:27], v[112:115], v[184:199]
    ds_read_b64_tr_b16 v[20:21], v11 offset:16384
    ds_read_b64_tr_b16 v[22:23], v11 offset:17408
    v_cvt_pk_bf16_f32 v163, v174, v175
    s_mul_i32 s36, s60, 384
    s_add_u32 s36, s36, s38
    buffer_store_dwordx4 v[160:163], v10, s[20:23], s36 offen offset:0 sc1
    v_mfma_f32_32x32x16_bf16 v[184:199], v[28:31], v[116:119], v[184:199]
    ds_read_b64_tr_b16 v[24:25], v11 offset:18432
    ds_read_b64_tr_b16 v[26:27], v11 offset:19456
    v_cvt_pk_bf16_f32 v164, v176, v177
    s_setprio 0
    s_waitcnt lgkmcnt(4)
    v_mfma_f32_32x32x16_bf16 v[184:199], v[204:207], v[120:123], v[184:199]
    ds_read_b64_tr_b16 v[28:29], v3 offset:0
    ds_read_b64_tr_b16 v[30:31], v3 offset:1024
    v_cvt_pk_bf16_f32 v165, v178, v179
    v_mfma_f32_32x32x16_bf16 v[184:199], v[16:19], v[124:127], v[184:199]
    ds_read_b64_tr_b16 v[204:205], v3 offset:2048
    ds_read_b64_tr_b16 v[206:207], v3 offset:3072
    v_cvt_pk_bf16_f32 v166, v180, v181
    s_waitcnt lgkmcnt(4)
    v_mfma_f32_32x32x16_bf16 v[184:199], v[20:23], v[128:131], v[184:199]
    s_waitcnt vmcnt(14)
    s_barrier
    ds_read_b64_tr_b16 v[16:17], v3 offset:8192
    ds_read_b64_tr_b16 v[18:19], v3 offset:9216
    v_cvt_pk_bf16_f32 v167, v182, v183
    s_mul_i32 s36, s60, 384
    s_add_u32 s36, s36, s38
    buffer_store_dwordx4 v[164:167], v10, s[20:23], s36 offen offset:1024 sc1
    v_mfma_f32_32x32x16_bf16 v[184:199], v[24:27], v[132:135], v[184:199]
    ds_read_b64_tr_b16 v[20:21], v3 offset:10240
    ds_read_b64_tr_b16 v[22:23], v3 offset:11264
    v_add_u32 v2, 122880, v4
    v_add_u32 v11, 122880, v5
    s_setprio 2
    s_waitcnt lgkmcnt(4)
    v_mfma_f32_32x32x16_bf16 v[184:199], v[28:31], v[88:91], v[184:199]
    ds_read_b64_tr_b16 v[24:25], v3 offset:16384
    ds_read_b64_tr_b16 v[26:27], v3 offset:17408
    s_add_u32 m0, s65, 0
    s_add_u32 s36, s50, s64
    buffer_load_dwordx4 v7, s[12:15], s36 offen  lds
    s_lshl_b32 s41, s44, 5
    v_mfma_f32_32x32x16_bf16 v[184:199], v[204:207], v[92:95], v[184:199]
    ds_read_b64_tr_b16 v[28:29], v3 offset:18432
    ds_read_b64_tr_b16 v[30:31], v3 offset:19456
    s_add_u32 m0, s65, 1024
    s_add_u32 s36, s51, s64
    buffer_load_dwordx4 v7, s[12:15], s36 offen  lds
    s_add_u32 s42, s41, 31
    s_waitcnt lgkmcnt(4)
    v_mfma_f32_32x32x16_bf16 v[184:199], v[16:19], v[96:99], v[184:199]
    ds_read_b64_tr_b16 v[204:205], v12 offset:0
    ds_read_b64_tr_b16 v[206:207], v12 offset:1024
    s_add_u32 m0, s65, 2048
    s_add_u32 s36, s52, s64
    buffer_load_dwordx4 v7, s[12:15], s36 offen  lds
    s_mul_i32 s41, s41, 7282
    v_mfma_f32_32x32x16_bf16 v[184:199], v[20:23], v[100:103], v[184:199]
    ds_read_b64_tr_b16 v[16:17], v12 offset:2048
    ds_read_b64_tr_b16 v[18:19], v12 offset:3072
    s_lshr_b32 s41, s41, 16
    s_mul_i32 s42, s42, 7282
    s_setprio 1
    s_waitcnt lgkmcnt(4)
    v_mfma_f32_32x32x16_bf16 v[184:199], v[24:27], v[104:107], v[184:199]
    ds_read_b64_tr_b16 v[20:21], v12 offset:8192
    ds_read_b64_tr_b16 v[22:23], v12 offset:9216
    s_lshr_b32 s42, s42, 16
    v_mfma_f32_32x32x16_bf16 v[184:199], v[28:31], v[108:111], v[184:199]
    ds_read_b64_tr_b16 v[24:25], v12 offset:10240
    ds_read_b64_tr_b16 v[26:27], v12 offset:11264
    v_add_u32 v238, s41, v1
    s_waitcnt lgkmcnt(4)
    v_mfma_f32_32x32x16_bf16 v[184:199], v[204:207], v[136:139], v[184:199]
    ds_read_b64_tr_b16 v[28:29], v12 offset:16384
    ds_read_b64_tr_b16 v[30:31], v12 offset:17408
    v_min_u32 v238, s42, v238
    v_mfma_f32_32x32x16_bf16 v[184:199], v[16:19], v[140:143], v[184:199]
    ds_read_b64_tr_b16 v[204:205], v12 offset:18432
    ds_read_b64_tr_b16 v[206:207], v12 offset:19456
    s_lshl_b32 s41, s32, 2
    s_add_u32 s41, s41, s47
    s_setprio 0
    s_waitcnt lgkmcnt(4)
    v_mfma_f32_32x32x16_bf16 v[184:199], v[20:23], v[144:147], v[184:199]
    ds_read_b64_tr_b16 v[16:17], v2 offset:0
    ds_read_b64_tr_b16 v[18:19], v2 offset:1024
    v_mov_b32 v237, s41
    v_cmp_gt_u32 vcc, 8, v1
    s_nop 1
    v_cndmask_b32 v238, v237, v238, vcc
    v_mfma_f32_32x32x16_bf16 v[184:199], v[24:27], v[148:151], v[184:199]
    ds_read_b64_tr_b16 v[20:21], v2 offset:2048
    ds_read_b64_tr_b16 v[22:23], v2 offset:3072
    v_lshlrev_b32 v238, 8, v238
    s_waitcnt lgkmcnt(4)
    v_mfma_f32_32x32x16_bf16 v[184:199], v[28:31], v[152:155], v[184:199]
    s_waitcnt vmcnt(14)
    s_waitcnt vmcnt(12)
    s_barrier
    ds_read_b64_tr_b16 v[24:25], v2 offset:8192
    ds_read_b64_tr_b16 v[26:27], v2 offset:9216
    v_add_u32 v238, 33554432, v238
    buffer_load_dword v234, v238, s[20:23], 0 offen sc1
    v_mfma_f32_32x32x16_bf16 v[184:199], v[204:207], v[156:159], v[184:199]
    ds_read_b64_tr_b16 v[28:29], v2 offset:10240
    ds_read_b64_tr_b16 v[30:31], v2 offset:11264
    v_add_u32 v3, 49152, v4
    v_add_u32 v12, 49152, v5
    s_setprio 2
    s_waitcnt lgkmcnt(4)
    v_mfma_f32_32x32x16_bf16 v[168:183], v[16:19], v[64:67], 0
    ds_read_b64_tr_b16 v[204:205], v2 offset:16384
    ds_read_b64_tr_b16 v[206:207], v2 offset:17408
    s_add_u32 m0, s65, 24576
    s_add_u32 s36, s53, s64
    buffer_load_dwordx4 v7, s[12:15], s36 offen  lds
    v_mfma_f32_32x32x16_bf16 v[168:183], v[20:23], v[68:71], v[168:183]
    ds_read_b64_tr_b16 v[16:17], v2 offset:18432
    ds_read_b64_tr_b16 v[18:19], v2 offset:19456
    s_add_u32 m0, s65, 25600
    s_add_u32 s36, s54, s64
    buffer_load_dwordx4 v7, s[12:15], s36 offen  lds
    s_mul_i32 s36, s59, 24
    s_add_u32 s36, s36, s67
    buffer_store_dword v200, v201, s[20:23], s36 offen sc1
    s_waitcnt lgkmcnt(4)
    v_mfma_f32_32x32x16_bf16 v[168:183], v[24:27], v[72:75], v[168:183]
    ds_read_b64_tr_b16 v[20:21], v11 offset:0
    ds_read_b64_tr_b16 v[22:23], v11 offset:1024
    s_add_u32 m0, s65, 26624
    s_add_u32 s36, s55, s64
    buffer_load_dwordx4 v7, s[12:15], s36 offen  lds
    v_mfma_f32_32x32x16_bf16 v[168:183], v[28:31], v[76:79], v[168:183]
    ds_read_b64_tr_b16 v[24:25], v11 offset:2048
    ds_read_b64_tr_b16 v[26:27], v11 offset:3072
    v_cvt_pk_bf16_f32 v160, v184, v185
    s_setprio 1
    s_waitcnt lgkmcnt(4)
    v_mfma_f32_32x32x16_bf16 v[168:183], v[204:207], v[80:83], v[168:183]
    ds_read_b64_tr_b16 v[28:29], v11 offset:8192
    ds_read_b64_tr_b16 v[30:31], v11 offset:9216
    v_cvt_pk_bf16_f32 v161, v186, v187
    v_mfma_f32_32x32x16_bf16 v[168:183], v[16:19], v[84:87], v[168:183]
    ds_read_b64_tr_b16 v[204:205], v11 offset:10240
    ds_read_b64_tr_b16 v[206:207], v11 offset:11264
    v_cvt_pk_bf16_f32 v162, v188, v189
    s_waitcnt lgkmcnt(4)
    v_mfma_f32_32x32x16_bf16 v[168:183], v[20:23], v[112:115], v[168:183]
    ds_read_b64_tr_b16 v[16:17], v11 offset:16384
    ds_read_b64_tr_b16 v[18:19], v11 offset:17408
    v_cvt_pk_bf16_f32 v163, v190, v191
    s_mul_i32 s36, s61, 384
    s_add_u32 s36, s36, s38
    buffer_store_dwordx4 v[160:163], v10, s[20:23], s36 offen offset:0 sc1
    v_mfma_f32_32x32x16_bf16 v[168:183], v[24:27], v[116:119], v[168:183]
    ds_read_b64_tr_b16 v[20:21], v11 offset:18432
    ds_read_b64_tr_b16 v[22:23], v11 offset:19456
    v_cvt_pk_bf16_f32 v164, v192, v193
    s_setprio 0
    s_waitcnt lgkmcnt(4)
    v_mfma_f32_32x32x16_bf16 v[168:183], v[28:31], v[120:123], v[168:183]
    ds_read_b64_tr_b16 v[24:25], v3 offset:0
    ds_read_b64_tr_b16 v[26:27], v3 offset:1024
    v_cvt_pk_bf16_f32 v165, v194, v195
    v_mfma_f32_32x32x16_bf16 v[168:183], v[204:207], v[124:127], v[168:183]
    ds_read_b64_tr_b16 v[28:29], v3 offset:2048
    ds_read_b64_tr_b16 v[30:31], v3 offset:3072
    v_cvt_pk_bf16_f32 v166, v196, v197
    s_waitcnt lgkmcnt(4)
    v_mfma_f32_32x32x16_bf16 v[168:183], v[16:19], v[128:131], v[168:183]
    s_waitcnt vmcnt(15)
    s_barrier
    ds_read_b64_tr_b16 v[204:205], v3 offset:8192
    ds_read_b64_tr_b16 v[206:207], v3 offset:9216
    v_cvt_pk_bf16_f32 v167, v198, v199
    s_mul_i32 s36, s61, 384
    s_add_u32 s36, s36, s38
    buffer_store_dwordx4 v[164:167], v10, s[20:23], s36 offen offset:1024 sc1
    v_mfma_f32_32x32x16_bf16 v[168:183], v[20:23], v[132:135], v[168:183]
    ds_read_b64_tr_b16 v[16:17], v3 offset:10240
    ds_read_b64_tr_b16 v[18:19], v3 offset:11264
    v_add_u32 v2, 98304, v4
    v_add_u32 v11, 98304, v5
    s_setprio 2
    s_waitcnt lgkmcnt(4)
    v_mfma_f32_32x32x16_bf16 v[168:183], v[24:27], v[88:91], v[168:183]
    ds_read_b64_tr_b16 v[20:21], v3 offset:16384
    ds_read_b64_tr_b16 v[22:23], v3 offset:17408
    v_mfma_f32_32x32x16_bf16 v[168:183], v[28:31], v[92:95], v[168:183]
    ds_read_b64_tr_b16 v[24:25], v3 offset:18432
    ds_read_b64_tr_b16 v[26:27], v3 offset:19456
    s_waitcnt vmcnt(6)
Lffn_cpoll:
    v_cmp_eq_u32 vcc, s66, v234
    s_nop 1
    s_cmp_eq_u64 vcc, -1
    s_cbranch_scc1 Lffn_cready
    s_sleep 8
    buffer_load_dword v234, v238, s[20:23], 0 offen sc1
    s_waitcnt vmcnt(0)
    s_add_u32 s39, s39, 1
    s_cmp_lt_u32 s39, 0x40000
    s_cbranch_scc1 Lffn_cpoll
Lffn_cready:
    s_waitcnt lgkmcnt(4)
    v_mfma_f32_32x32x16_bf16 v[168:183], v[204:207], v[96:99], v[168:183]
    ds_read_b64_tr_b16 v[28:29], v12 offset:0
    ds_read_b64_tr_b16 v[30:31], v12 offset:1024
    v_lshrrev_b32 v232, 2, v1
    v_mfma_f32_32x32x16_bf16 v[168:183], v[16:19], v[100:103], v[168:183]
    ds_read_b64_tr_b16 v[204:205], v12 offset:2048
    ds_read_b64_tr_b16 v[206:207], v12 offset:3072
    s_setprio 1
    s_waitcnt lgkmcnt(4)
    v_mfma_f32_32x32x16_bf16 v[168:183], v[20:23], v[104:107], v[168:183]
    ds_read_b64_tr_b16 v[16:17], v12 offset:8192
    ds_read_b64_tr_b16 v[18:19], v12 offset:9216
    v_lshlrev_b32 v232, 12, v232
    v_mfma_f32_32x32x16_bf16 v[168:183], v[24:27], v[108:111], v[168:183]
    ds_read_b64_tr_b16 v[20:21], v12 offset:10240
    ds_read_b64_tr_b16 v[22:23], v12 offset:11264
    v_and_b32 v236, 3, v1
    s_waitcnt lgkmcnt(4)
    v_mfma_f32_32x32x16_bf16 v[168:183], v[28:31], v[136:139], v[168:183]
    ds_read_b64_tr_b16 v[24:25], v12 offset:16384
    ds_read_b64_tr_b16 v[26:27], v12 offset:17408
    v_lshl_add_u32 v232, v236, 4, v232
    v_mfma_f32_32x32x16_bf16 v[168:183], v[204:207], v[140:143], v[168:183]
    ds_read_b64_tr_b16 v[28:29], v12 offset:18432
    ds_read_b64_tr_b16 v[30:31], v12 offset:19456
    s_setprio 0
    s_waitcnt lgkmcnt(4)
    v_mfma_f32_32x32x16_bf16 v[168:183], v[16:19], v[144:147], v[168:183]
    ds_read_b64_tr_b16 v[204:205], v2 offset:0
    ds_read_b64_tr_b16 v[206:207], v2 offset:1024
    buffer_load_dwordx4 v[40:43], v232, s[20:23], s49 offen sc1
    v_mfma_f32_32x32x16_bf16 v[168:183], v[20:23], v[148:151], v[168:183]
    ds_read_b64_tr_b16 v[16:17], v2 offset:2048
    ds_read_b64_tr_b16 v[18:19], v2 offset:3072
    s_add_u32 s41, s49, 65536
    s_waitcnt lgkmcnt(4)
    v_mfma_f32_32x32x16_bf16 v[168:183], v[24:27], v[152:155], v[168:183]
    s_barrier
    ds_read_b64_tr_b16 v[20:21], v2 offset:8192
    ds_read_b64_tr_b16 v[22:23], v2 offset:9216
    buffer_load_dwordx4 v[44:47], v232, s[20:23], s41 offen sc1
    v_mfma_f32_32x32x16_bf16 v[168:183], v[28:31], v[156:159], v[168:183]
    ds_read_b64_tr_b16 v[24:25], v2 offset:10240
    ds_read_b64_tr_b16 v[26:27], v2 offset:11264
    v_add_u32 v3, 73728, v4
    v_add_u32 v12, 73728, v5
    s_setprio 2
    s_waitcnt lgkmcnt(4)
    v_mfma_f32_32x32x16_bf16 v[184:199], v[204:207], v[64:67], 0
    ds_read_b64_tr_b16 v[28:29], v2 offset:16384
    ds_read_b64_tr_b16 v[30:31], v2 offset:17408
    v_mfma_f32_32x32x16_bf16 v[184:199], v[16:19], v[68:71], v[184:199]
    ds_read_b64_tr_b16 v[204:205], v2 offset:18432
    ds_read_b64_tr_b16 v[206:207], v2 offset:19456
    s_mul_i32 s36, s60, 24
    s_add_u32 s36, s36, s67
    buffer_store_dword v200, v201, s[20:23], s36 offen sc1
    s_waitcnt lgkmcnt(4)
    v_mfma_f32_32x32x16_bf16 v[184:199], v[20:23], v[72:75], v[184:199]
    ds_read_b64_tr_b16 v[16:17], v11 offset:0
    ds_read_b64_tr_b16 v[18:19], v11 offset:1024
    v_mfma_f32_32x32x16_bf16 v[184:199], v[24:27], v[76:79], v[184:199]
    ds_read_b64_tr_b16 v[20:21], v11 offset:2048
    ds_read_b64_tr_b16 v[22:23], v11 offset:3072
    v_cvt_pk_bf16_f32 v160, v168, v169
    s_setprio 1
    s_waitcnt lgkmcnt(4)
    v_mfma_f32_32x32x16_bf16 v[184:199], v[28:31], v[80:83], v[184:199]
    ds_read_b64_tr_b16 v[24:25], v11 offset:8192
    ds_read_b64_tr_b16 v[26:27], v11 offset:9216
    v_cvt_pk_bf16_f32 v161, v170, v171
    v_mfma_f32_32x32x16_bf16 v[184:199], v[204:207], v[84:87], v[184:199]
    ds_read_b64_tr_b16 v[28:29], v11 offset:10240
    ds_read_b64_tr_b16 v[30:31], v11 offset:11264
    v_cvt_pk_bf16_f32 v162, v172, v173
    s_waitcnt lgkmcnt(4)
    v_mfma_f32_32x32x16_bf16 v[184:199], v[16:19], v[112:115], v[184:199]
    ds_read_b64_tr_b16 v[204:205], v11 offset:16384
    ds_read_b64_tr_b16 v[206:207], v11 offset:17408
    v_cvt_pk_bf16_f32 v163, v174, v175
    s_mul_i32 s36, s62, 384
    s_add_u32 s36, s36, s38
    buffer_store_dwordx4 v[160:163], v10, s[20:23], s36 offen offset:0 sc1
    v_mfma_f32_32x32x16_bf16 v[184:199], v[20:23], v[116:119], v[184:199]
    ds_read_b64_tr_b16 v[16:17], v11 offset:18432
    ds_read_b64_tr_b16 v[18:19], v11 offset:19456
    v_cvt_pk_bf16_f32 v164, v176, v177
    s_setprio 0
    s_waitcnt lgkmcnt(4)
    v_mfma_f32_32x32x16_bf16 v[184:199], v[24:27], v[120:123], v[184:199]
    ds_read_b64_tr_b16 v[20:21], v3 offset:0
    ds_read_b64_tr_b16 v[22:23], v3 offset:1024
    v_cvt_pk_bf16_f32 v165, v178, v179
    v_mfma_f32_32x32x16_bf16 v[184:199], v[28:31], v[124:127], v[184:199]
    ds_read_b64_tr_b16 v[24:25], v3 offset:2048
    ds_read_b64_tr_b16 v[26:27], v3 offset:3072
    v_cvt_pk_bf16_f32 v166, v180, v181
    s_waitcnt lgkmcnt(4)
    v_mfma_f32_32x32x16_bf16 v[184:199], v[204:207], v[128:131], v[184:199]
    s_barrier
    ds_read_b64_tr_b16 v[28:29], v3 offset:8192
    ds_read_b64_tr_b16 v[30:31], v3 offset:9216
    v_cvt_pk_bf16_f32 v167, v182, v183
    s_mul_i32 s36, s62, 384
    s_add_u32 s36, s36, s38
    buffer_store_dwordx4 v[164:167], v10, s[20:23], s36 offen offset:1024 sc1
    v_mfma_f32_32x32x16_bf16 v[184:199], v[16:19], v[132:135], v[184:199]
    ds_read_b64_tr_b16 v[204:205], v3 offset:10240
    ds_read_b64_tr_b16 v[206:207], v3 offset:11264
    v_add_u32 v2, 0, v4
    v_add_u32 v11, 0, v5
    s_setprio 2
    s_waitcnt lgkmcnt(4)
    v_mfma_f32_32x32x16_bf16 v[184:199], v[20:23], v[88:91], v[184:199]
    ds_read_b64_tr_b16 v[16:17], v3 offset:16384
    ds_read_b64_tr_b16 v[18:19], v3 offset:17408
    v_lshrrev_b32 v235, 5, v1
    v_mfma_f32_32x32x16_bf16 v[184:199], v[24:27], v[92:95], v[184:199]
    ds_read_b64_tr_b16 v[20:21], v3 offset:18432
    ds_read_b64_tr_b16 v[22:23], v3 offset:19456
    v_and_b32 v236, 31, v1
    s_waitcnt lgkmcnt(4)
    v_mfma_f32_32x32x16_bf16 v[184:199], v[28:31], v[96:99], v[184:199]
    ds_read_b64_tr_b16 v[24:25], v12 offset:0
    ds_read_b64_tr_b16 v[26:27], v12 offset:1024
    v_mul_u32_u24 v230, 1152, v236
    v_mfma_f32_32x32x16_bf16 v[184:199], v[204:207], v[100:103], v[184:199]
    ds_read_b64_tr_b16 v[28:29], v12 offset:2048
    ds_read_b64_tr_b16 v[30:31], v12 offset:3072
    v_lshl_add_u32 v230, v235, 4, v230
    v_lshlrev_b32 v231, 4, v1
    s_setprio 1
    s_waitcnt lgkmcnt(4)
    v_mfma_f32_32x32x16_bf16 v[184:199], v[16:19], v[104:107], v[184:199]
    ds_read_b64_tr_b16 v[204:205], v12 offset:8192
    ds_read_b64_tr_b16 v[206:207], v12 offset:9216
    v_lshlrev_b32 v236, 2, v236
    v_mfma_f32_32x32x16_bf16 v[184:199], v[20:23], v[108:111], v[184:199]
    ds_read_b64_tr_b16 v[16:17], v12 offset:10240
    ds_read_b64_tr_b16 v[18:19], v12 offset:11264
    v_lshlrev_b32 v237, 3, v235
    s_waitcnt lgkmcnt(4)
    v_mfma_f32_32x32x16_bf16 v[184:199], v[24:27], v[136:139], v[184:199]
    ds_read_b64_tr_b16 v[20:21], v12 offset:16384
    ds_read_b64_tr_b16 v[22:23], v12 offset:17408
    buffer_load_dword v228, v236, s[20:23], s33 offen sc1
    v_mfma_f32_32x32x16_bf16 v[184:199], v[28:31], v[140:143], v[184:199]
    ds_read_b64_tr_b16 v[24:25], v12 offset:18432
    ds_read_b64_tr_b16 v[26:27], v12 offset:19456
    buffer_load_dwordx2 v[220:221], v237, s[24:27], s34 offen offset:0
    buffer_load_dwordx2 v[222:223], v237, s[24:27], s34 offen offset:16
    s_setprio 0
    s_waitcnt lgkmcnt(4)
    v_mfma_f32_32x32x16_bf16 v[184:199], v[204:207], v[144:147], v[184:199]
    ds_read_b64_tr_b16 v[28:29], v2 offset:0
    ds_read_b64_tr_b16 v[30:31], v2 offset:1024
    buffer_load_dwordx2 v[224:225], v237, s[24:27], s34 offen offset:32
    v_mfma_f32_32x32x16_bf16 v[184:199], v[16:19], v[148:151], v[184:199]
    ds_read_b64_tr_b16 v[204:205], v2 offset:2048
    ds_read_b64_tr_b16 v[206:207], v2 offset:3072
    buffer_load_dwordx2 v[226:227], v237, s[24:27], s34 offen offset:48
    s_waitcnt lgkmcnt(4)
    v_mfma_f32_32x32x16_bf16 v[184:199], v[20:23], v[152:155], v[184:199]
    s_waitcnt vmcnt(12)
    s_waitcnt vmcnt(10)
    s_barrier
    ds_read_b64_tr_b16 v[16:17], v2 offset:8192
    ds_read_b64_tr_b16 v[18:19], v2 offset:9216
    buffer_load_dwordx4 v[32:35], v230, s[16:19], s46 offen offset:0
    buffer_load_dwordx4 v[36:39], v230, s[16:19], s46 offen offset:32
    v_mfma_f32_32x32x16_bf16 v[184:199], v[24:27], v[156:159], v[184:199]
    ds_read_b64_tr_b16 v[20:21], v2 offset:10240
    ds_read_b64_tr_b16 v[22:23], v2 offset:11264
    v_add_u32 v3, 24576, v4
    v_add_u32 v12, 24576, v5
    s_setprio 2
    s_waitcnt lgkmcnt(4)
    v_mfma_f32_32x32x16_bf16 v[168:183], v[28:31], v[64:67], 0
    ds_read_b64_tr_b16 v[24:25], v2 offset:16384
    ds_read_b64_tr_b16 v[26:27], v2 offset:17408
    v_mfma_f32_32x32x16_bf16 v[168:183], v[204:207], v[68:71], v[168:183]
    ds_read_b64_tr_b16 v[28:29], v2 offset:18432
    ds_read_b64_tr_b16 v[30:31], v2 offset:19456
    s_mul_i32 s36, s61, 24
    s_add_u32 s36, s36, s67
    buffer_store_dword v200, v201, s[20:23], s36 offen sc1
    s_waitcnt lgkmcnt(4)
    v_mfma_f32_32x32x16_bf16 v[168:183], v[16:19], v[72:75], v[168:183]
    ds_read_b64_tr_b16 v[204:205], v11 offset:0
    ds_read_b64_tr_b16 v[206:207], v11 offset:1024
    v_mfma_f32_32x32x16_bf16 v[168:183], v[20:23], v[76:79], v[168:183]
    ds_read_b64_tr_b16 v[16:17], v11 offset:2048
    ds_read_b64_tr_b16 v[18:19], v11 offset:3072
    v_cvt_pk_bf16_f32 v160, v184, v185
    s_setprio 1
    s_waitcnt lgkmcnt(4)
    v_mfma_f32_32x32x16_bf16 v[168:183], v[24:27], v[80:83], v[168:183]
    ds_read_b64_tr_b16 v[20:21], v11 offset:8192
    ds_read_b64_tr_b16 v[22:23], v11 offset:9216
    v_cvt_pk_bf16_f32 v161, v186, v187
    v_mfma_f32_32x32x16_bf16 v[168:183], v[28:31], v[84:87], v[168:183]
    ds_read_b64_tr_b16 v[24:25], v11 offset:10240
    ds_read_b64_tr_b16 v[26:27], v11 offset:11264
    v_cvt_pk_bf16_f32 v162, v188, v189
    s_waitcnt lgkmcnt(4)
    v_mfma_f32_32x32x16_bf16 v[168:183], v[204:207], v[112:115], v[168:183]
    ds_read_b64_tr_b16 v[28:29], v11 offset:16384
    ds_read_b64_tr_b16 v[30:31], v11 offset:17408
    v_cvt_pk_bf16_f32 v163, v190, v191
    s_mul_i32 s36, s63, 384
    s_add_u32 s36, s36, s38
    buffer_store_dwordx4 v[160:163], v10, s[20:23], s36 offen offset:0 sc1
    v_mfma_f32_32x32x16_bf16 v[168:183], v[16:19], v[116:119], v[168:183]
    ds_read_b64_tr_b16 v[204:205], v11 offset:18432
    ds_read_b64_tr_b16 v[206:207], v11 offset:19456
    v_cvt_pk_bf16_f32 v164, v192, v193
    s_setprio 0
    s_waitcnt lgkmcnt(4)
    v_mfma_f32_32x32x16_bf16 v[168:183], v[20:23], v[120:123], v[168:183]
    ds_read_b64_tr_b16 v[16:17], v3 offset:0
    ds_read_b64_tr_b16 v[18:19], v3 offset:1024
    v_cvt_pk_bf16_f32 v165, v194, v195
    v_mfma_f32_32x32x16_bf16 v[168:183], v[24:27], v[124:127], v[168:183]
    ds_read_b64_tr_b16 v[20:21], v3 offset:2048
    ds_read_b64_tr_b16 v[22:23], v3 offset:3072
    v_cvt_pk_bf16_f32 v166, v196, v197
    s_waitcnt lgkmcnt(4)
    v_mfma_f32_32x32x16_bf16 v[168:183], v[28:31], v[128:131], v[168:183]
    s_waitcnt vmcnt(9)
    s_barrier
    ds_read_b64_tr_b16 v[24:25], v3 offset:8192
    ds_read_b64_tr_b16 v[26:27], v3 offset:9216
    v_cvt_pk_bf16_f32 v167, v198, v199
    s_mul_i32 s36, s63, 384
    s_add_u32 s36, s36, s38
    buffer_store_dwordx4 v[164:167], v10, s[20:23], s36 offen offset:1024 sc1
    v_mfma_f32_32x32x16_bf16 v[168:183], v[204:207], v[132:135], v[168:183]
    ds_read_b64_tr_b16 v[28:29], v3 offset:10240
    ds_read_b64_tr_b16 v[30:31], v3 offset:11264
    s_setprio 2
    s_waitcnt lgkmcnt(4)
    v_mfma_f32_32x32x16_bf16 v[168:183], v[16:19], v[88:91], v[168:183]
    ds_read_b64_tr_b16 v[204:205], v3 offset:16384
    ds_read_b64_tr_b16 v[206:207], v3 offset:17408
    v_mfma_f32_32x32x16_bf16 v[168:183], v[20:23], v[92:95], v[168:183]
    ds_read_b64_tr_b16 v[16:17], v3 offset:18432
    ds_read_b64_tr_b16 v[18:19], v3 offset:19456
    s_mul_i32 s36, s62, 24
    s_add_u32 s36, s36, s67
    buffer_store_dword v200, v201, s[20:23], s36 offen sc1
    s_waitcnt lgkmcnt(4)
    v_mfma_f32_32x32x16_bf16 v[168:183], v[24:27], v[96:99], v[168:183]
    ds_read_b64_tr_b16 v[20:21], v12 offset:0
    ds_read_b64_tr_b16 v[22:23], v12 offset:1024
    v_mfma_f32_32x32x16_bf16 v[168:183], v[28:31], v[100:103], v[168:183]
    ds_read_b64_tr_b16 v[24:25], v12 offset:2048
    ds_read_b64_tr_b16 v[26:27], v12 offset:3072
    s_setprio 1
    s_waitcnt lgkmcnt(4)
    v_mfma_f32_32x32x16_bf16 v[168:183], v[204:207], v[104:107], v[168:183]
    ds_read_b64_tr_b16 v[28:29], v12 offset:8192
    ds_read_b64_tr_b16 v[30:31], v12 offset:9216
    v_mfma_f32_32x32x16_bf16 v[168:183], v[16:19], v[108:111], v[168:183]
    ds_read_b64_tr_b16 v[204:205], v12 offset:10240
    ds_read_b64_tr_b16 v[206:207], v12 offset:11264
    s_waitcnt lgkmcnt(4)
    v_mfma_f32_32x32x16_bf16 v[168:183], v[20:23], v[136:139], v[168:183]
    ds_read_b64_tr_b16 v[16:17], v12 offset:16384
    ds_read_b64_tr_b16 v[18:19], v12 offset:17408
    v_mfma_f32_32x32x16_bf16 v[168:183], v[24:27], v[140:143], v[168:183]
    ds_read_b64_tr_b16 v[20:21], v12 offset:18432
    ds_read_b64_tr_b16 v[22:23], v12 offset:19456
    s_setprio 0
    s_waitcnt lgkmcnt(4)
    v_mfma_f32_32x32x16_bf16 v[168:183], v[28:31], v[144:147], v[168:183]
    v_mfma_f32_32x32x16_bf16 v[168:183], v[204:207], v[148:151], v[168:183]
    s_waitcnt lgkmcnt(0)
    v_mfma_f32_32x32x16_bf16 v[168:183], v[16:19], v[152:155], v[168:183]
    v_mfma_f32_32x32x16_bf16 v[168:183], v[20:23], v[156:159], v[168:183]
    s_nop 11
    v_cvt_pk_bf16_f32 v160, v168, v169
    v_cvt_pk_bf16_f32 v161, v170, v171
    v_cvt_pk_bf16_f32 v162, v172, v173
    v_cvt_pk_bf16_f32 v163, v174, v175
    s_mul_i32 s36, s64, 384
    s_add_u32 s36, s36, s38
    buffer_store_dwordx4 v[160:163], v10, s[20:23], s36 offen offset:0 sc1
    v_cvt_pk_bf16_f32 v164, v176, v177
    v_cvt_pk_bf16_f32 v165, v178, v179
    v_cvt_pk_bf16_f32 v166, v180, v181
    v_cvt_pk_bf16_f32 v167, v182, v183
    s_mul_i32 s36, s64, 384
    s_add_u32 s36, s36, s38
    buffer_store_dwordx4 v[164:167], v10, s[20:23], s36 offen offset:1024 sc1
    s_cmp_lt_u32 s40, 40
    s_cbranch_scc0 Lffn_nounit
    v_and_b32 v236, 31, v1
    v_lshrrev_b32 v237, 5, v1
    v_lshlrev_b32 v237, 2, v237
    v_sub_u32 v236, v236, v237
    v_mov_b32 v232, 0x3f80
    v_mov_b32 v233, 0x3f800000
    v_cmp_eq_u32 vcc, 0, v236
    s_nop 1
    v_cndmask_b32 v240, 0, v232, vcc
    v_cmp_eq_u32 vcc, 1, v236
    s_nop 1
    v_cndmask_b32 v240, v240, v233, vcc
    v_cmp_eq_u32 vcc, 2, v236
    s_nop 1
    v_cndmask_b32 v241, 0, v232, vcc
    v_cmp_eq_u32 vcc, 3, v236
    s_nop 1
    v_cndmask_b32 v241, v241, v233, vcc
    v_cmp_eq_u32 vcc, 8, v236
    s_nop 1
    v_cndmask_b32 v242, 0, v232, vcc
    v_cmp_eq_u32 vcc, 9, v236
    s_nop 1
    v_cndmask_b32 v242, v242, v233, vcc
    v_cmp_eq_u32 vcc, 10, v236
    s_nop 1
    v_cndmask_b32 v243, 0, v232, vcc
    v_cmp_eq_u32 vcc, 11, v236
    s_nop 1
    v_cndmask_b32 v243, v243, v233, vcc
    v_cmp_eq_u32 vcc, 16, v236
    s_nop 1
    v_cndmask_b32 v244, 0, v232, vcc
    v_cmp_eq_u32 vcc, 17, v236
    s_nop 1
    v_cndmask_b32 v244, v244, v233, vcc
    v_cmp_eq_u32 vcc, 18, v236
    s_nop 1
    v_cndmask_b32 v245, 0, v232, vcc
    v_cmp_eq_u32 vcc, 19, v236
    s_nop 1
    v_cndmask_b32 v245, v245, v233, vcc
    v_cmp_eq_u32 vcc, 24, v236
    s_nop 1
    v_cndmask_b32 v246, 0, v232, vcc
    v_cmp_eq_u32 vcc, 25, v236
    s_nop 1
    v_cndmask_b32 v246, v246, v233, vcc
    v_cmp_eq_u32 vcc, 26, v236
    s_nop 1
    v_cndmask_b32 v247, 0, v232, vcc
    v_cmp_eq_u32 vcc, 27, v236
    s_nop 1
    v_cndmask_b32 v247, v247, v233, vcc
    s_waitcnt vmcnt(6)
    v_permlane32_swap_b32 v32, v34
    v_permlane32_swap_b32 v33, v35
    v_permlane32_swap_b32 v36, v38
    v_permlane32_swap_b32 v37, v39
    v_sub_f32 v229, 1.0, v228
    v_lshlrev_b32 v202, 16, v32
    v_and_b32 v203, 0xffff0000, v32
    v_lshlrev_b32 v204, 16, v33
    v_and_b32 v205, 0xffff0000, v33
    v_lshlrev_b32 v206, 16, v34
    v_and_b32 v207, 0xffff0000, v34
    v_lshlrev_b32 v208, 16, v35
    v_and_b32 v209, 0xffff0000, v35
    v_lshlrev_b32 v210, 16, v36
    v_and_b32 v211, 0xffff0000, v36
    v_lshlrev_b32 v212, 16, v37
    v_and_b32 v213, 0xffff0000, v37
    v_lshlrev_b32 v214, 16, v38
    v_and_b32 v215, 0xffff0000, v38
    v_lshlrev_b32 v216, 16, v39
    v_and_b32 v217, 0xffff0000, v39
    v_mul_f32 v202, v202, v228
    v_mul_f32 v203, v203, v228
    v_mul_f32 v204, v204, v228
    v_mul_f32 v205, v205, v228
    v_mul_f32 v206, v206, v228
    v_mul_f32 v207, v207, v228
    v_mul_f32 v208, v208, v228
    v_mul_f32 v209, v209, v228
    v_mul_f32 v210, v210, v228
    v_mul_f32 v211, v211, v228
    v_mul_f32 v212, v212, v228
    v_mul_f32 v213, v213, v228
    v_mul_f32 v214, v214, v228
    v_mul_f32 v215, v215, v228
    v_mul_f32 v216, v216, v228
    v_mul_f32 v217, v217, v228
    v_add_u32 v234, s48, v231
    v_and_b32 v236, 15, v1
    v_lshrrev_b32 v233, 2, v236
    v_lshrrev_b32 v237, 5, v1
    v_lshl_add_u32 v233, v237, 2, v233
    v_lshlrev_b32 v233, 6, v233
    v_and_b32 v236, 3, v236
    v_lshl_add_u32 v233, v236, 3, v233
    v_lshrrev_b32 v236, 4, v1
    v_and_b32 v236, 1, v236
    v_lshl_add_u32 v233, v236, 5, v233
    v_add_u32 v233, s48, v233
    ds_write_b128 v234, v[40:43]
    ds_write_b128 v234, v[44:47] offset:1024
    s_waitcnt lgkmcnt(0)
    ds_read_b64_tr_b16 v[48:49], v233 offset:0
    ds_read_b64_tr_b16 v[50:51], v233 offset:512
    ds_read_b64_tr_b16 v[52:53], v233 offset:1024
    ds_read_b64_tr_b16 v[54:55], v233 offset:1536
    s_waitcnt lgkmcnt(0)
    v_lshlrev_b32 v32, 16, v48
    v_and_b32 v33, 0xffff0000, v48
    v_lshlrev_b32 v34, 16, v49
    v_and_b32 v35, 0xffff0000, v49
    v_lshlrev_b32 v36, 16, v50
    v_and_b32 v37, 0xffff0000, v50
    v_lshlrev_b32 v38, 16, v51
    v_and_b32 v39, 0xffff0000, v51
    v_lshlrev_b32 v40, 16, v52
    v_and_b32 v41, 0xffff0000, v52
    v_lshlrev_b32 v42, 16, v53
    v_and_b32 v43, 0xffff0000, v53
    v_lshlrev_b32 v44, 16, v54
    v_and_b32 v45, 0xffff0000, v54
    v_lshlrev_b32 v46, 16, v55
    v_and_b32 v47, 0xffff0000, v55
    v_mul_f32 v202, v202, v32
    v_mul_f32 v203, v203, v33
    v_mul_f32 v204, v204, v34
    v_mul_f32 v205, v205, v35
    v_mul_f32 v206, v206, v36
    v_mul_f32 v207, v207, v37
    v_mul_f32 v208, v208, v38
    v_mul_f32 v209, v209, v39
    v_mul_f32 v210, v210, v40
    v_mul_f32 v211, v211, v41
    v_mul_f32 v212, v212, v42
    v_mul_f32 v213, v213, v43
    v_mul_f32 v214, v214, v44
    v_mul_f32 v215, v215, v45
    v_mul_f32 v216, v216, v46
    v_mul_f32 v217, v217, v47
Lffn_nounit:
    s_waitcnt vmcnt(0) lgkmcnt(0)
    s_barrier
    s_mul_i32 s36, s63, 24
    s_add_u32 s36, s36, s67
    buffer_store_dword v200, v201, s[20:23], s36 offen sc1
    s_mul_i32 s36, s64, 24
    s_add_u32 s36, s36, s67
    buffer_store_dword v200, v201, s[20:23], s36 offen sc1
    s_cmp_lt_u32 s40, 40
    s_cbranch_scc1 Lffn_unit
    s_waitcnt vmcnt(0)
    s_endpgm
Lffn_unit:
    s_mul_i32 s53, s32, 9
    s_lshr_b32 s41, s44, 1
    s_add_u32 s53, s53, s41
    s_mul_i32 s53, s53, 3072
    s_add_u32 s53, s53, 33038336
    v_min_u32 v12, 11, v1
    v_lshlrev_b32 v12, 8, v12
    v_mfma_f32_32x32x16_bf16 v[32:47], v[240:243], v[220:223], 0
    v_mfma_f32_32x32x16_bf16 v[32:47], v[244:247], v[224:227], v[32:47]
Lffn_fpoll:
    buffer_load_dword v14, v12, s[20:23], s53 offen sc1
    s_waitcnt vmcnt(0)
    v_cmp_eq_u32 vcc, s66, v14
    s_nop 1
    s_cmp_eq_u64 vcc, -1
    s_cbranch_scc1 Lffn_fready
    s_sleep 2
    s_add_u32 s39, s39, 1
    s_cmp_lt_u32 s39, 0x40000
    s_cbranch_scc1 Lffn_fpoll
Lffn_fready:
    buffer_load_dwordx4 v[64:67], v231, s[20:23], s45 offen offset:0 sc1
    buffer_load_dwordx4 v[68:71], v231, s[20:23], s45 offen offset:1024 sc1
    buffer_load_dwordx4 v[72:75], v231, s[20:23], s45 offen offset:2048 sc1
    buffer_load_dwordx4 v[76:79], v231, s[20:23], s45 offen offset:3072 sc1
    s_add_u32 s45, s45, 4096
    buffer_load_dwordx4 v[80:83], v231, s[20:23], s45 offen offset:0 sc1
    buffer_load_dwordx4 v[84:87], v231, s[20:23], s45 offen offset:1024 sc1
    buffer_load_dwordx4 v[88:91], v231, s[20:23], s45 offen offset:2048 sc1
    buffer_load_dwordx4 v[92:95], v231, s[20:23], s45 offen offset:3072 sc1
    s_add_u32 s45, s45, 4096
    buffer_load_dwordx4 v[96:99], v231, s[20:23], s45 offen offset:0 sc1
    buffer_load_dwordx4 v[100:103], v231, s[20:23], s45 offen offset:1024 sc1
    buffer_load_dwordx4 v[104:107], v231, s[20:23], s45 offen offset:2048 sc1
    buffer_load_dwordx4 v[108:111], v231, s[20:23], s45 offen offset:3072 sc1
    s_add_u32 s45, s45, 4096
    buffer_load_dwordx4 v[112:115], v231, s[20:23], s45 offen offset:0 sc1
    buffer_load_dwordx4 v[116:119], v231, s[20:23], s45 offen offset:1024 sc1
    buffer_load_dwordx4 v[120:123], v231, s[20:23], s45 offen offset:2048 sc1
    buffer_load_dwordx4 v[124:127], v231, s[20:23], s45 offen offset:3072 sc1
    s_add_u32 s45, s45, 4096
    buffer_load_dwordx4 v[128:131], v231, s[20:23], s45 offen offset:0 sc1
    buffer_load_dwordx4 v[132:135], v231, s[20:23], s45 offen offset:1024 sc1
    buffer_load_dwordx4 v[136:139], v231, s[20:23], s45 offen offset:2048 sc1
    buffer_load_dwordx4 v[140:143], v231, s[20:23], s45 offen offset:3072 sc1
    s_add_u32 s45, s45, 4096
    buffer_load_dwordx4 v[144:147], v231, s[20:23], s45 offen offset:0 sc1
    buffer_load_dwordx4 v[148:151], v231, s[20:23], s45 offen offset:1024 sc1
    buffer_load_dwordx4 v[152:155], v231, s[20:23], s45 offen offset:2048 sc1
    buffer_load_dwordx4 v[156:159], v231, s[20:23], s45 offen offset:3072 sc1
    s_waitcnt vmcnt(23)
    v_mfma_f32_32x32x16_bf16 v[32:47], v[240:243], v[64:67], v[32:47]
    s_waitcnt vmcnt(22)
    v_mfma_f32_32x32x16_bf16 v[32:47], v[244:247], v[68:71], v[32:47]
    s_waitcnt vmcnt(21)
    v_mfma_f32_32x32x16_bf16 v[32:47], v[240:243], v[72:75], v[32:47]
    s_waitcnt vmcnt(20)
    v_mfma_f32_32x32x16_bf16 v[32:47], v[244:247], v[76:79], v[32:47]
    s_waitcnt vmcnt(19)
    v_mfma_f32_32x32x16_bf16 v[32:47], v[240:243], v[80:83], v[32:47]
    s_waitcnt vmcnt(18)
    v_mfma_f32_32x32x16_bf16 v[32:47], v[244:247], v[84:87], v[32:47]
    s_waitcnt vmcnt(17)
    v_mfma_f32_32x32x16_bf16 v[32:47], v[240:243], v[88:91], v[32:47]
    s_waitcnt vmcnt(16)
    v_mfma_f32_32x32x16_bf16 v[32:47], v[244:247], v[92:95], v[32:47]
    s_waitcnt vmcnt(15)
    v_mfma_f32_32x32x16_bf16 v[32:47], v[240:243], v[96:99], v[32:47]
    s_waitcnt vmcnt(14)
    v_mfma_f32_32x32x16_bf16 v[32:47], v[244:247], v[100:103], v[32:47]
    s_waitcnt vmcnt(13)
    v_mfma_f32_32x32x16_bf16 v[32:47], v[240:243], v[104:107], v[32:47]
    s_waitcnt vmcnt(12)
    v_mfma_f32_32x32x16_bf16 v[32:47], v[244:247], v[108:111], v[32:47]
    s_waitcnt vmcnt(11)
    v_mfma_f32_32x32x16_bf16 v[32:47], v[240:243], v[112:115], v[32:47]
    s_waitcnt vmcnt(10)
    v_mfma_f32_32x32x16_bf16 v[32:47], v[244:247], v[116:119], v[32:47]
    s_waitcnt vmcnt(9)
    v_mfma_f32_32x32x16_bf16 v[32:47], v[240:243], v[120:123], v[32:47]
    s_waitcnt vmcnt(8)
    v_mfma_f32_32x32x16_bf16 v[32:47], v[244:247], v[124:127], v[32:47]
    s_waitcnt vmcnt(7)
    v_mfma_f32_32x32x16_bf16 v[32:47], v[240:243], v[128:131], v[32:47]
    s_waitcnt vmcnt(6)
    v_mfma_f32_32x32x16_bf16 v[32:47], v[244:247], v[132:135], v[32:47]
    s_waitcnt vmcnt(5)
    v_mfma_f32_32x32x16_bf16 v[32:47], v[240:243], v[136:139], v[32:47]
    s_waitcnt vmcnt(4)
    v_mfma_f32_32x32x16_bf16 v[32:47], v[244:247], v[140:143], v[32:47]
    s_waitcnt vmcnt(3)
    v_mfma_f32_32x32x16_bf16 v[32:47], v[240:243], v[144:147], v[32:47]
    s_waitcnt vmcnt(2)
    v_mfma_f32_32x32x16_bf16 v[32:47], v[244:247], v[148:151], v[32:47]
    s_waitcnt vmcnt(1)
    v_mfma_f32_32x32x16_bf16 v[32:47], v[240:243], v[152:155], v[32:47]
    s_waitcnt vmcnt(0)
    v_mfma_f32_32x32x16_bf16 v[32:47], v[244:247], v[156:159], v[32:47]
    s_nop 7
    s_nop 3
    v_fma_f32 v32, v32, v229, v202
    v_fma_f32 v33, v33, v229, v203
    v_fma_f32 v34, v34, v229, v204
    v_fma_f32 v35, v35, v229, v205
    v_fma_f32 v36, v36, v229, v206
    v_fma_f32 v37, v37, v229, v207
    v_fma_f32 v38, v38, v229, v208
    v_fma_f32 v39, v39, v229, v209
    v_fma_f32 v40, v40, v229, v210
    v_fma_f32 v41, v41, v229, v211
    v_fma_f32 v42, v42, v229, v212
    v_fma_f32 v43, v43, v229, v213
    v_fma_f32 v44, v44, v229, v214
    v_fma_f32 v45, v45, v229, v215
    v_fma_f32 v46, v46, v229, v216
    v_fma_f32 v47, v47, v229, v217
    v_cvt_pk_bf16_f32 v48, v32, v33
    v_cvt_pk_bf16_f32 v49, v34, v35
    v_cvt_pk_bf16_f32 v50, v36, v37
    v_cvt_pk_bf16_f32 v51, v38, v39
    v_cvt_pk_bf16_f32 v52, v40, v41
    v_cvt_pk_bf16_f32 v53, v42, v43
    v_cvt_pk_bf16_f32 v54, v44, v45
    v_cvt_pk_bf16_f32 v55, v46, v47
    s_nop 1
    v_permlane32_swap_b32 v48, v50
    v_permlane32_swap_b32 v49, v51
    v_permlane32_swap_b32 v52, v54
    v_permlane32_swap_b32 v53, v55
    buffer_store_dwordx4 v[48:51], v230, s[8:11], s46 offen offset:0
    buffer_store_dwordx4 v[52:55], v230, s[8:11], s46 offen offset:32
    s_waitcnt vmcnt(0)
    s_endpgm

Lk1_ssm:
    s_sub_u32 s29, s2, 192
    s_mov_b32 s7, 0
    s_load_dwordx2 s[40:41], s[0:1], 32
    s_load_dwordx2 s[12:13], s[0:1], 8
    s_load_dwordx2 s[16:17], s[0:1], 16
    s_load_dwordx2 s[24:25], s[0:1], 24
    s_load_dwordx2 s[8:9], s[0:1], 0
    s_load_dwordx2 s[20:21], s[0:1], 112
    s_load_dwordx2 s[44:45], s[0:1], 88
    s_load_dwordx2 s[48:49], s[0:1], 104
    s_load_dwordx2 s[52:53], s[0:1], 40
    s_load_dwordx2 s[56:57], s[0:1], 80
    s_load_dwordx2 s[60:61], s[0:1], 96
    s_memrealtime s[34:35]
    v_and_b32 v1, 63, v0
    v_lshrrev_b32 v2, 6, v0
    s_nop 0
    v_readfirstlane_b32 s28, v2
    s_mov_b32 s42, 2359296
    s_mov_b32 s43, 0x00020000
    s_mov_b32 s14, 2359296
    s_mov_b32 s15, 0x00020000
    s_mov_b32 s18, 2359296
    s_mov_b32 s19, 0x00020000
    s_mov_b32 s26, 4608
    s_mov_b32 s27, 0x00020000
    s_mov_b32 s10, 2359296
    s_mov_b32 s11, 0x00020000
    s_mov_b32 s22, 33759232
    s_mov_b32 s23, 0x00020000
    s_mov_b32 s46, 1152
    s_mov_b32 s47, 0x00020000
    s_mov_b32 s50, 256
    s_mov_b32 s51, 0x00020000
    s_mov_b32 s54, 1152
    s_mov_b32 s55, 0x00020000
    s_mov_b32 s58, 1152
    s_mov_b32 s59, 0x00020000
    s_mov_b32 s62, 2359296
    s_mov_b32 s63, 0x00020000
    s_mul_i32 s31, s29, 9
    s_add_u32 s33, s31, 8
    s_add_u32 s31, s31, s28
    s_waitcnt lgkmcnt(0)
    s_and_b32 s41, s41, 0xffff
    s_and_b32 s13, s13, 0xffff
    s_and_b32 s17, s17, 0xffff
    s_and_b32 s25, s25, 0xffff
    s_and_b32 s9, s9, 0xffff
    s_and_b32 s21, s21, 0xffff
    s_and_b32 s45, s45, 0xffff
    s_and_b32 s49, s49, 0xffff
    s_and_b32 s53, s53, 0xffff
    s_and_b32 s57, s57, 0xffff
    s_and_b32 s61, s61, 0xffff
    s_or_b32 s34, s34, 1
    s_add_u32 s36, s29, s28
    s_cmp_eq_u32 s36, 0
    s_cbranch_scc0 Lssm_nononce
    v_mov_b32 v2, s34
    v_mov_b32 v3, 0
    buffer_store_dword v2, v3, s[48:51], 0 offen offset:128 sc1
Lssm_nononce:
    s_cmp_lt_u32 s28, 4
    s_cbranch_scc0 Lssm_gate_done
    s_lshl_b32 s36, s29, 5
    s_and_b32 s37, s28, 3
    s_lshl_b32 s37, s37, 3
    s_add_u32 s36, s36, s37
    v_and_b32 v2, 7, v1
    v_lshrrev_b32 v3, 3, v1
    v_add_u32 v4, s36, v3
    v_mul_u32_u24 v6, 1152, v4
    v_lshl_add_u32 v6, v2, 4, v6
    v_lshlrev_b32 v7, 4, v2
    buffer_load_dwordx4 v[16:19], v6, s[8:11], 0 offen offset:0
    buffer_load_dwordx4 v[20:23], v6, s[8:11], 0 offen offset:128
    buffer_load_dwordx4 v[24:27], v6, s[8:11], 0 offen offset:256
    buffer_load_dwordx4 v[28:31], v6, s[8:11], 0 offen offset:384
    buffer_load_dwordx4 v[32:35], v6, s[8:11], 0 offen offset:512
    buffer_load_dwordx4 v[36:39], v6, s[8:11], 0 offen offset:640
    buffer_load_dwordx4 v[40:43], v6, s[8:11], 0 offen offset:768
    buffer_load_dwordx4 v[44:47], v6, s[8:11], 0 offen offset:896
    buffer_load_dwordx4 v[48:51], v6, s[8:11], 0 offen offset:1024
    buffer_load_dwordx4 v[60:63], v7, s[44:47], 0 offen offset:0
    buffer_load_dwordx4 v[64:67], v7, s[44:47], 0 offen offset:128
    buffer_load_dwordx4 v[68:71], v7, s[44:47], 0 offen offset:256
    buffer_load_dwordx4 v[72:75], v7, s[44:47], 0 offen offset:384
    buffer_load_dwordx4 v[76:79], v7, s[44:47], 0 offen offset:512
    buffer_load_dwordx4 v[80:83], v7, s[44:47], 0 offen offset:640
    buffer_load_dwordx4 v[84:87], v7, s[44:47], 0 offen offset:768
    buffer_load_dwordx4 v[88:91], v7, s[44:47], 0 offen offset:896
    buffer_load_dwordx4 v[92:95], v7, s[44:47], 0 offen offset:1024
    v_mov_b32 v8, 0
    v_mov_b32 v9, 0
    s_waitcnt vmcnt(0)
    v_lshlrev_b32 v10, 16, v16
    v_lshlrev_b32 v11, 16, v60
    v_and_b32 v12, 0xffff0000, v16
    v_and_b32 v14, 0xffff0000, v60
    v_fmac_f32 v8, v10, v11
    v_fmac_f32 v9, v12, v14
    v_lshlrev_b32 v10, 16, v17
    v_lshlrev_b32 v11, 16, v61
    v_and_b32 v12, 0xffff0000, v17
    v_and_b32 v14, 0xffff0000, v61
    v_fmac_f32 v8, v10, v11
    v_fmac_f32 v9, v12, v14
    v_lshlrev_b32 v10, 16, v18
    v_lshlrev_b32 v11, 16, v62
    v_and_b32 v12, 0xffff0000, v18
    v_and_b32 v14, 0xffff0000, v62
    v_fmac_f32 v8, v10, v11
    v_fmac_f32 v9, v12, v14
    v_lshlrev_b32 v10, 16, v19
    v_lshlrev_b32 v11, 16, v63
    v_and_b32 v12, 0xffff0000, v19
    v_and_b32 v14, 0xffff0000, v63
    v_fmac_f32 v8, v10, v11
    v_fmac_f32 v9, v12, v14
    v_lshlrev_b32 v10, 16, v20
    v_lshlrev_b32 v11, 16, v64
    v_and_b32 v12, 0xffff0000, v20
    v_and_b32 v14, 0xffff0000, v64
    v_fmac_f32 v8, v10, v11
    v_fmac_f32 v9, v12, v14
    v_lshlrev_b32 v10, 16, v21
    v_lshlrev_b32 v11, 16, v65
    v_and_b32 v12, 0xffff0000, v21
    v_and_b32 v14, 0xffff0000, v65
    v_fmac_f32 v8, v10, v11
    v_fmac_f32 v9, v12, v14
    v_lshlrev_b32 v10, 16, v22
    v_lshlrev_b32 v11, 16, v66
    v_and_b32 v12, 0xffff0000, v22
    v_and_b32 v14, 0xffff0000, v66
    v_fmac_f32 v8, v10, v11
    v_fmac_f32 v9, v12, v14
    v_lshlrev_b32 v10, 16, v23
    v_lshlrev_b32 v11, 16, v67
    v_and_b32 v12, 0xffff0000, v23
    v_and_b32 v14, 0xffff0000, v67
    v_fmac_f32 v8, v10, v11
    v_fmac_f32 v9, v12, v14
    v_lshlrev_b32 v10, 16, v24
    v_lshlrev_b32 v11, 16, v68
    v_and_b32 v12, 0xffff0000, v24
    v_and_b32 v14, 0xffff0000, v68
    v_fmac_f32 v8, v10, v11
    v_fmac_f32 v9, v12, v14
    v_lshlrev_b32 v10, 16, v25
    v_lshlrev_b32 v11, 16, v69
    v_and_b32 v12, 0xffff0000, v25
    v_and_b32 v14, 0xffff0000, v69
    v_fmac_f32 v8, v10, v11
    v_fmac_f32 v9, v12, v14
    v_lshlrev_b32 v10, 16, v26
    v_lshlrev_b32 v11, 16, v70
    v_and_b32 v12, 0xffff0000, v26
    v_and_b32 v14, 0xffff0000, v70
    v_fmac_f32 v8, v10, v11
    v_fmac_f32 v9, v12, v14
    v_lshlrev_b32 v10, 16, v27
    v_lshlrev_b32 v11, 16, v71
    v_and_b32 v12, 0xffff0000, v27
    v_and_b32 v14, 0xffff0000, v71
    v_fmac_f32 v8, v10, v11
    v_fmac_f32 v9, v12, v14
    v_lshlrev_b32 v10, 16, v28
    v_lshlrev_b32 v11, 16, v72
    v_and_b32 v12, 0xffff0000, v28
    v_and_b32 v14, 0xffff0000, v72
    v_fmac_f32 v8, v10, v11
    v_fmac_f32 v9, v12, v14
    v_lshlrev_b32 v10, 16, v29
    v_lshlrev_b32 v11, 16, v73
    v_and_b32 v12, 0xffff0000, v29
    v_and_b32 v14, 0xffff0000, v73
    v_fmac_f32 v8, v10, v11
    v_fmac_f32 v9, v12, v14
    v_lshlrev_b32 v10, 16, v30
    v_lshlrev_b32 v11, 16, v74
    v_and_b32 v12, 0xffff0000, v30
    v_and_b32 v14, 0xffff0000, v74
    v_fmac_f32 v8, v10, v11
    v_fmac_f32 v9, v12, v14
    v_lshlrev_b32 v10, 16, v31
    v_lshlrev_b32 v11, 16, v75
    v_and_b32 v12, 0xffff0000, v31
    v_and_b32 v14, 0xffff0000, v75
    v_fmac_f32 v8, v10, v11
    v_fmac_f32 v9, v12, v14
    v_lshlrev_b32 v10, 16, v32
    v_lshlrev_b32 v11, 16, v76
    v_and_b32 v12, 0xffff0000, v32
    v_and_b32 v14, 0xffff0000, v76
    v_fmac_f32 v8, v10, v11
    v_fmac_f32 v9, v12, v14
    v_lshlrev_b32 v10, 16, v33
    v_lshlrev_b32 v11, 16, v77
    v_and_b32 v12, 0xffff0000, v33
    v_and_b32 v14, 0xffff0000, v77
    v_fmac_f32 v8, v10, v11
    v_fmac_f32 v9, v12, v14
    v_lshlrev_b32 v10, 16, v34
    v_lshlrev_b32 v11, 16, v78
    v_and_b32 v12, 0xffff0000, v34
    v_and_b32 v14, 0xffff0000, v78
    v_fmac_f32 v8, v10, v11
    v_fmac_f32 v9, v12, v14
    v_lshlrev_b32 v10, 16, v35
    v_lshlrev_b32 v11, 16, v79
    v_and_b32 v12, 0xffff0000, v35
    v_and_b32 v14, 0xffff0000, v79
    v_fmac_f32 v8, v10, v11
    v_fmac_f32 v9, v12, v14
    v_lshlrev_b32 v10, 16, v36
    v_lshlrev_b32 v11, 16, v80
    v_and_b32 v12, 0xffff0000, v36
    v_and_b32 v14, 0xffff0000, v80
    v_fmac_f32 v8, v10, v11
    v_fmac_f32 v9, v12, v14
    v_lshlrev_b32 v10, 16, v37
    v_lshlrev_b32 v11, 16, v81
    v_and_b32 v12, 0xffff0000, v37
    v_and_b32 v14, 0xffff0000, v81
    v_fmac_f32 v8, v10, v11
    v_fmac_f32 v9, v12, v14
    v_lshlrev_b32 v10, 16, v38
    v_lshlrev_b32 v11, 16, v82
    v_and_b32 v12, 0xffff0000, v38
    v_and_b32 v14, 0xffff0000, v82
    v_fmac_f32 v8, v10, v11
    v_fmac_f32 v9, v12, v14
    v_lshlrev_b32 v10, 16, v39
    v_lshlrev_b32 v11, 16, v83
    v_and_b32 v12, 0xffff0000, v39
    v_and_b32 v14, 0xffff0000, v83
    v_fmac_f32 v8, v10, v11
    v_fmac_f32 v9, v12, v14
    v_lshlrev_b32 v10, 16, v40
    v_lshlrev_b32 v11, 16, v84
    v_and_b32 v12, 0xffff0000, v40
    v_and_b32 v14, 0xffff0000, v84
    v_fmac_f32 v8, v10, v11
    v_fmac_f32 v9, v12, v14
    v_lshlrev_b32 v10, 16, v41
    v_lshlrev_b32 v11, 16, v85
    v_and_b32 v12, 0xffff0000, v41
    v_and_b32 v14, 0xffff0000, v85
    v_fmac_f32 v8, v10, v11
    v_fmac_f32 v9, v12, v14
    v_lshlrev_b32 v10, 16, v42
    v_lshlrev_b32 v11, 16, v86
    v_and_b32 v12, 0xffff0000, v42
    v_and_b32 v14, 0xffff0000, v86
    v_fmac_f32 v8, v10, v11
    v_fmac_f32 v9, v12, v14
    v_lshlrev_b32 v10, 16, v43
    v_lshlrev_b32 v11, 16, v87
    v_and_b32 v12, 0xffff0000, v43
    v_and_b32 v14, 0xffff0000, v87
    v_fmac_f32 v8, v10, v11
    v_fmac_f32 v9, v12, v14
    v_lshlrev_b32 v10, 16, v44
    v_lshlrev_b32 v11, 16, v88
    v_and_b32 v12, 0xffff0000, v44
    v_and_b32 v14, 0xffff0000, v88
    v_fmac_f32 v8, v10, v11
    v_fmac_f32 v9, v12, v14
    v_lshlrev_b32 v10, 16, v45
    v_lshlrev_b32 v11, 16, v89
    v_and_b32 v12, 0xffff0000, v45
    v_and_b32 v14, 0xffff0000, v89
    v_fmac_f32 v8, v10, v11
    v_fmac_f32 v9, v12, v14
    v_lshlrev_b32 v10, 16, v46
    v_lshlrev_b32 v11, 16, v90
    v_and_b32 v12, 0xffff0000, v46
    v_and_b32 v14, 0xffff0000, v90
    v_fmac_f32 v8, v10, v11
    v_fmac_f32 v9, v12, v14
    v_lshlrev_b32 v10, 16, v47
    v_lshlrev_b32 v11, 16, v91
    v_and_b32 v12, 0xffff0000, v47
    v_and_b32 v14, 0xffff0000, v91
    v_fmac_f32 v8, v10, v11
    v_fmac_f32 v9, v12, v14
    v_lshlrev_b32 v10, 16, v48
    v_lshlrev_b32 v11, 16, v92
    v_and_b32 v12, 0xffff0000, v48
    v_and_b32 v14, 0xffff0000, v92
    v_fmac_f32 v8, v10, v11
    v_fmac_f32 v9, v12, v14
    v_lshlrev_b32 v10, 16, v49
    v_lshlrev_b32 v11, 16, v93
    v_and_b32 v12, 0xffff0000, v49
    v_and_b32 v14, 0xffff0000, v93
    v_fmac_f32 v8, v10, v11
    v_fmac_f32 v9, v12, v14
    v_lshlrev_b32 v10, 16, v50
    v_lshlrev_b32 v11, 16, v94
    v_and_b32 v12, 0xffff0000, v50
    v_and_b32 v14, 0xffff0000, v94
    v_fmac_f32 v8, v10, v11
    v_fmac_f32 v9, v12, v14
    v_lshlrev_b32 v10, 16, v51
    v_lshlrev_b32 v11, 16, v95
    v_and_b32 v12, 0xffff0000, v51
    v_and_b32 v14, 0xffff0000, v95
    v_fmac_f32 v8, v10, v11
    v_fmac_f32 v9, v12, v14
    v_add_f32 v8, v8, v9
    ds_swizzle_b32 v9, v8 offset:0x41f
    s_waitcnt lgkmcnt(0)
    v_add_f32 v8, v8, v9
    ds_swizzle_b32 v9, v8 offset:0x81f
    s_waitcnt lgkmcnt(0)
    v_add_f32 v8, v8, v9
    ds_swizzle_b32 v9, v8 offset:0x101f
    s_waitcnt lgkmcnt(0)
    v_add_f32 v8, v8, v9
    v_mul_f32 v8, 0xbfb8aa3b, v8
    v_exp_f32 v8, v8
    s_nop 0
    v_add_f32 v8, 1.0, v8
    v_rcp_f32 v8, v8
    v_lshlrev_b32 v10, 2, v4
    s_mov_b32 s35, 33030144
    v_cmp_eq_u32 vcc, 0, v2
    s_and_saveexec_b64 s[38:39], vcc
    buffer_store_dword v8, v10, s[20:23], s35 offen sc1
    s_mov_b64 exec, s[38:39]
Lssm_gate_done:
    s_lshl_b32 s30, s29, 2
    s_add_u32 s30, s30, s28
    s_cmp_lt_u32 s28, 4
    s_cbranch_scc1 Lssm_prep
    s_add_u32 s30, s29, 256
    s_cmp_eq_u32 s28, 4
    s_cbranch_scc0 Lssm_noprep
    s_cmp_lt_u32 s29, 32
    s_cbranch_scc1 Lssm_prep
Lssm_noprep:
    s_cmp_lt_u32 s28, 5
    s_cbranch_scc1 Lssm_nopf1
    s_load_dwordx2 s[12:13], s[0:1], 56
    s_mov_b32 s14, 5308416
    s_mov_b32 s15, 0x00020000
    s_lshr_b32 s36, s29, 3
    s_mul_i32 s36, s36, 3
    s_add_u32 s36, s36, s28
    s_sub_u32 s36, s36, 5
    s_and_b32 s37, s29, 1
    s_lshl_b32 s37, s37, 10
    s_mul_i32 s35, s36, 43
    s_add_u32 s37, s37, s35
    s_mul_i32 s37, s37, 1152
    s_add_u32 s37, s37, 768
    v_mul_u32_u24 v12, 21846, v1
    v_lshrrev_b32 v12, 16, v12
    v_mul_u32_u24 v13, 3, v12
    v_sub_u32 v13, v1, v13
    v_mul_u32_u24 v12, 1152, v12
    v_lshl_add_u32 v12, v13, 7, v12
    s_sub_u32 s35, s37, 384
    buffer_load_dword v210, v12, s[8:11], s35 offen
    s_add_u32 s35, s35, 24192
    buffer_load_dword v211, v12, s[8:11], s35 offen
    s_add_u32 s35, s35, 24192
    buffer_load_dword v200, v12, s[8:11], s37 offen
    s_add_u32 s37, s37, 24192
    buffer_load_dword v201, v12, s[8:11], s37 offen
    s_add_u32 s37, s37, 24192
    s_and_b32 s37, s29, 7
    s_lshr_b32 s37, s37, 1
    s_mul_i32 s37, s37, 2304
    v_mul_u32_u24 v12, 21846, v1
    v_lshrrev_b32 v12, 16, v12
    v_mul_u32_u24 v13, 3, v12
    v_sub_u32 v13, v1, v13
    v_mul_u32_u24 v13, 768, v13
    v_mul_u32_u24 v12, 9216, v12
    v_add_u32 v12, v12, v13
    s_waitcnt lgkmcnt(0)
    s_and_b32 s13, s13, 0xffff
    s_mul_i32 s35, s36, 73728
    s_add_u32 s35, s35, s37
    s_add_u32 s35, s35, 3538944
    buffer_load_dword v202, v12, s[12:15], s35 offen
    v_mul_u32_u24 v12, 4370, v1
    v_lshrrev_b32 v12, 16, v12
    v_mul_u32_u24 v13, 15, v12
    v_sub_u32 v13, v1, v13
    v_mul_u32_u24 v14, 13108, v13
    v_lshrrev_b32 v14, 16, v14
    v_mul_u32_u24 v15, 5, v14
    v_sub_u32 v13, v13, v15
    v_mul_u32_u24 v14, 768, v14
    v_lshl_add_u32 v14, v13, 7, v14
    v_add_u32 v14, 128, v14
    v_mul_u32_u24 v12, 9216, v12
    v_add_u32 v12, v12, v14
    s_mul_i32 s35, s36, 147456
    s_add_u32 s35, s35, s37
    buffer_load_dword v203, v12, s[12:15], s35 offen
    s_add_u32 s35, s35, 36864
    buffer_load_dword v204, v12, s[12:15], s35 offen
    s_add_u32 s35, s35, 36864
    buffer_load_dword v205, v12, s[12:15], s35 offen
    s_add_u32 s35, s35, 36864
    buffer_load_dword v206, v12, s[12:15], s35 offen
    s_add_u32 s35, s35, 36864
Lssm_nopf1:
    s_mov_b32 s4, -1
    s_waitcnt vmcnt(0)
    s_branch Lssm_hb
Lssm_prep:
    s_mul_hi_u32 s36, s30, 477218589
    s_mul_i32 s37, s36, 9
    s_sub_u32 s37, s30, s37
    s_lshl_b32 s4, s37, 5
    s_add_u32 s4, s4, s36
    s_lshl_b32 s4, s4, 8
    s_add_u32 s4, s4, 33480704
    s_lshl_b32 s36, s36, 6
    s_lshl_b32 s37, s37, 6
    v_and_b32 v2, 7, v1
    v_lshrrev_b32 v3, 3, v1
    v_lshl_add_u32 v4, v3, 3, s36
    v_lshl_add_u32 v5, v2, 3, s37
    v_mul_u32_u24 v6, 1152, v4
    v_lshl_add_u32 v6, v5, 1, v6
    v_subrev_u32 v7, 3456, v6
    v_cmp_eq_u32 vcc, 0, v4
    v_mov_b32 v8, 0x80000000
    s_nop 0
    v_cndmask_b32 v7, v7, v8, vcc
    v_lshlrev_b32 v8, 3, v5
    s_mov_b32 s35, 4608
    buffer_load_dwordx4 v[16:19], v7, s[12:15], 0 offen offset:0
    buffer_load_dwordx4 v[20:23], v7, s[12:15], 0 offen offset:1152
    buffer_load_dwordx4 v[24:27], v7, s[12:15], 0 offen offset:2304
    buffer_load_dwordx4 v[28:31], v6, s[12:15], 0 offen offset:0
    buffer_load_dwordx4 v[32:35], v6, s[12:15], 0 offen offset:1152
    buffer_load_dwordx4 v[36:39], v6, s[12:15], 0 offen offset:2304
    buffer_load_dwordx4 v[40:43], v6, s[12:15], 0 offen offset:3456
    buffer_load_dwordx4 v[44:47], v6, s[12:15], s35 offen offset:0
    buffer_load_dwordx4 v[48:51], v6, s[12:15], s35 offen offset:1152
    buffer_load_dwordx4 v[52:55], v6, s[12:15], s35 offen offset:2304
    buffer_load_dwordx4 v[56:59], v6, s[12:15], s35 offen offset:3456
    buffer_load_dwordx4 v[92:95], v8, s[24:27], 0 offen offset:0
    buffer_load_dwordx4 v[96:99], v8, s[24:27], 0 offen offset:16
    buffer_load_dwordx4 v[100:103], v8, s[24:27], 0 offen offset:32
    buffer_load_dwordx4 v[104:107], v8, s[24:27], 0 offen offset:48
    buffer_load_dwordx4 v[60:63], v6, s[16:19], 0 offen offset:0
    buffer_load_dwordx4 v[64:67], v6, s[16:19], 0 offen offset:1152
    buffer_load_dwordx4 v[68:71], v6, s[16:19], 0 offen offset:2304
    buffer_load_dwordx4 v[72:75], v6, s[16:19], 0 offen offset:3456
    buffer_load_dwordx4 v[76:79], v6, s[16:19], s35 offen offset:0
    buffer_load_dwordx4 v[80:83], v6, s[16:19], s35 offen offset:1152
    buffer_load_dwordx4 v[84:87], v6, s[16:19], s35 offen offset:2304
    buffer_load_dwordx4 v[88:91], v6, s[16:19], s35 offen offset:3456
    v_lshlrev_b32 v9, 12, v5
    v_lshlrev_b32 v10, 1, v4
    v_sub_u32 v9, v9, v10
    v_add_u32 v9, 4080, v9
    s_mov_b32 s35, 28311552
    s_waitcnt vmcnt(0)
    v_lshlrev_b32 v108, 16, v16
    v_and_b32 v109, 0xffff0000, v16
    v_lshlrev_b32 v110, 16, v20
    v_and_b32 v111, 0xffff0000, v20
    v_lshlrev_b32 v112, 16, v24
    v_and_b32 v113, 0xffff0000, v24
    v_lshlrev_b32 v114, 16, v28
    v_and_b32 v115, 0xffff0000, v28
    v_lshlrev_b32 v116, 16, v32
    v_and_b32 v117, 0xffff0000, v32
    v_lshlrev_b32 v118, 16, v36
    v_and_b32 v119, 0xffff0000, v36
    v_lshlrev_b32 v120, 16, v40
    v_and_b32 v121, 0xffff0000, v40
    v_lshlrev_b32 v122, 16, v44
    v_and_b32 v123, 0xffff0000, v44
    v_lshlrev_b32 v124, 16, v48
    v_and_b32 v125, 0xffff0000, v48
    v_lshlrev_b32 v126, 16, v52
    v_and_b32 v127, 0xffff0000, v52
    v_lshlrev_b32 v128, 16, v56
    v_and_b32 v129, 0xffff0000, v56
    v_lshlrev_b32 v146, 16, v92
    v_and_b32 v147, 0xffff0000, v92
    v_lshlrev_b32 v148, 16, v93
    v_and_b32 v149, 0xffff0000, v93
    v_lshlrev_b32 v150, 16, v94
    v_and_b32 v151, 0xffff0000, v94
    v_lshlrev_b32 v152, 16, v95
    v_and_b32 v153, 0xffff0000, v95
    v_lshlrev_b32 v130, 16, v60
    v_and_b32 v131, 0xffff0000, v60
    v_lshlrev_b32 v132, 16, v64
    v_and_b32 v133, 0xffff0000, v64
    v_lshlrev_b32 v134, 16, v68
    v_and_b32 v135, 0xffff0000, v68
    v_lshlrev_b32 v136, 16, v72
    v_and_b32 v137, 0xffff0000, v72
    v_lshlrev_b32 v138, 16, v76
    v_and_b32 v139, 0xffff0000, v76
    v_lshlrev_b32 v140, 16, v80
    v_and_b32 v141, 0xffff0000, v80
    v_lshlrev_b32 v142, 16, v84
    v_and_b32 v143, 0xffff0000, v84
    v_lshlrev_b32 v144, 16, v88
    v_and_b32 v145, 0xffff0000, v88
    v_mul_f32 v154, v108, v149
    v_mul_f32 v155, v109, v153
    v_mul_f32 v156, v110, v149
    v_mul_f32 v157, v111, v153
    v_mul_f32 v158, v112, v149
    v_mul_f32 v159, v113, v153
    v_mul_f32 v160, v114, v149
    v_mul_f32 v161, v115, v153
    v_mul_f32 v162, v116, v149
    v_mul_f32 v163, v117, v153
    v_mul_f32 v164, v118, v149
    v_mul_f32 v165, v119, v153
    v_mul_f32 v166, v120, v149
    v_mul_f32 v167, v121, v153
    v_mul_f32 v168, v122, v149
    v_mul_f32 v169, v123, v153
    v_fmac_f32 v154, v110, v148
    v_fmac_f32 v155, v111, v152
    v_fmac_f32 v156, v112, v148
    v_fmac_f32 v157, v113, v152
    v_fmac_f32 v158, v114, v148
    v_fmac_f32 v159, v115, v152
    v_fmac_f32 v160, v116, v148
    v_fmac_f32 v161, v117, v152
    v_fmac_f32 v162, v118, v148
    v_fmac_f32 v163, v119, v152
    v_fmac_f32 v164, v120, v148
    v_fmac_f32 v165, v121, v152
    v_fmac_f32 v166, v122, v148
    v_fmac_f32 v167, v123, v152
    v_fmac_f32 v168, v124, v148
    v_fmac_f32 v169, v125, v152
    v_fmac_f32 v154, v112, v147
    v_fmac_f32 v155, v113, v151
    v_fmac_f32 v156, v114, v147
    v_fmac_f32 v157, v115, v151
    v_fmac_f32 v158, v116, v147
    v_fmac_f32 v159, v117, v151
    v_fmac_f32 v160, v118, v147
    v_fmac_f32 v161, v119, v151
    v_fmac_f32 v162, v120, v147
    v_fmac_f32 v163, v121, v151
    v_fmac_f32 v164, v122, v147
    v_fmac_f32 v165, v123, v151
    v_fmac_f32 v166, v124, v147
    v_fmac_f32 v167, v125, v151
    v_fmac_f32 v168, v126, v147
    v_fmac_f32 v169, v127, v151
    v_fmac_f32 v154, v114, v146
    v_fmac_f32 v155, v115, v150
    v_fmac_f32 v156, v116, v146
    v_fmac_f32 v157, v117, v150
    v_fmac_f32 v158, v118, v146
    v_fmac_f32 v159, v119, v150
    v_fmac_f32 v160, v120, v146
    v_fmac_f32 v161, v121, v150
    v_fmac_f32 v162, v122, v146
    v_fmac_f32 v163, v123, v150
    v_fmac_f32 v164, v124, v146
    v_fmac_f32 v165, v125, v150
    v_fmac_f32 v166, v126, v146
    v_fmac_f32 v167, v127, v150
    v_fmac_f32 v168, v128, v146
    v_fmac_f32 v169, v129, v150
    v_mul_f32 v154, v154, v130
    v_mul_f32 v155, v155, v131
    v_mul_f32 v156, v156, v132
    v_mul_f32 v157, v157, v133
    v_mul_f32 v158, v158, v134
    v_mul_f32 v159, v159, v135
    v_mul_f32 v160, v160, v136
    v_mul_f32 v161, v161, v137
    v_mul_f32 v162, v162, v138
    v_mul_f32 v163, v163, v139
    v_mul_f32 v164, v164, v140
    v_mul_f32 v165, v165, v141
    v_mul_f32 v166, v166, v142
    v_mul_f32 v167, v167, v143
    v_mul_f32 v168, v168, v144
    v_mul_f32 v169, v169, v145
    v_cvt_pk_bf16_f32 v170, v168, v166
    v_cvt_pk_bf16_f32 v171, v164, v162
    v_cvt_pk_bf16_f32 v172, v160, v158
    v_cvt_pk_bf16_f32 v173, v156, v154
    v_cvt_pk_bf16_f32 v174, v169, v167
    v_cvt_pk_bf16_f32 v175, v165, v163
    v_cvt_pk_bf16_f32 v176, v161, v159
    v_cvt_pk_bf16_f32 v177, v157, v155
    buffer_store_dwordx4 v[170:173], v9, s[20:23], s35 offen sc1
    v_add_u32 v9, 4096, v9
    buffer_store_dwordx4 v[174:177], v9, s[20:23], s35 offen sc1
    v_add_u32 v9, 4096, v9
    s_nop 1
    v_lshlrev_b32 v108, 16, v17
    v_and_b32 v109, 0xffff0000, v17
    v_lshlrev_b32 v110, 16, v21
    v_and_b32 v111, 0xffff0000, v21
    v_lshlrev_b32 v112, 16, v25
    v_and_b32 v113, 0xffff0000, v25
    v_lshlrev_b32 v114, 16, v29
    v_and_b32 v115, 0xffff0000, v29
    v_lshlrev_b32 v116, 16, v33
    v_and_b32 v117, 0xffff0000, v33
    v_lshlrev_b32 v118, 16, v37
    v_and_b32 v119, 0xffff0000, v37
    v_lshlrev_b32 v120, 16, v41
    v_and_b32 v121, 0xffff0000, v41
    v_lshlrev_b32 v122, 16, v45
    v_and_b32 v123, 0xffff0000, v45
    v_lshlrev_b32 v124, 16, v49
    v_and_b32 v125, 0xffff0000, v49
    v_lshlrev_b32 v126, 16, v53
    v_and_b32 v127, 0xffff0000, v53
    v_lshlrev_b32 v128, 16, v57
    v_and_b32 v129, 0xffff0000, v57
    v_lshlrev_b32 v146, 16, v96
    v_and_b32 v147, 0xffff0000, v96
    v_lshlrev_b32 v148, 16, v97
    v_and_b32 v149, 0xffff0000, v97
    v_lshlrev_b32 v150, 16, v98
    v_and_b32 v151, 0xffff0000, v98
    v_lshlrev_b32 v152, 16, v99
    v_and_b32 v153, 0xffff0000, v99
    v_lshlrev_b32 v130, 16, v61
    v_and_b32 v131, 0xffff0000, v61
    v_lshlrev_b32 v132, 16, v65
    v_and_b32 v133, 0xffff0000, v65
    v_lshlrev_b32 v134, 16, v69
    v_and_b32 v135, 0xffff0000, v69
    v_lshlrev_b32 v136, 16, v73
    v_and_b32 v137, 0xffff0000, v73
    v_lshlrev_b32 v138, 16, v77
    v_and_b32 v139, 0xffff0000, v77
    v_lshlrev_b32 v140, 16, v81
    v_and_b32 v141, 0xffff0000, v81
    v_lshlrev_b32 v142, 16, v85
    v_and_b32 v143, 0xffff0000, v85
    v_lshlrev_b32 v144, 16, v89
    v_and_b32 v145, 0xffff0000, v89
    v_mul_f32 v154, v108, v149
    v_mul_f32 v155, v109, v153
    v_mul_f32 v156, v110, v149
    v_mul_f32 v157, v111, v153
    v_mul_f32 v158, v112, v149
    v_mul_f32 v159, v113, v153
    v_mul_f32 v160, v114, v149
    v_mul_f32 v161, v115, v153
    v_mul_f32 v162, v116, v149
    v_mul_f32 v163, v117, v153
    v_mul_f32 v164, v118, v149
    v_mul_f32 v165, v119, v153
    v_mul_f32 v166, v120, v149
    v_mul_f32 v167, v121, v153
    v_mul_f32 v168, v122, v149
    v_mul_f32 v169, v123, v153
    v_fmac_f32 v154, v110, v148
    v_fmac_f32 v155, v111, v152
    v_fmac_f32 v156, v112, v148
    v_fmac_f32 v157, v113, v152
    v_fmac_f32 v158, v114, v148
    v_fmac_f32 v159, v115, v152
    v_fmac_f32 v160, v116, v148
    v_fmac_f32 v161, v117, v152
    v_fmac_f32 v162, v118, v148
    v_fmac_f32 v163, v119, v152
    v_fmac_f32 v164, v120, v148
    v_fmac_f32 v165, v121, v152
    v_fmac_f32 v166, v122, v148
    v_fmac_f32 v167, v123, v152
    v_fmac_f32 v168, v124, v148
    v_fmac_f32 v169, v125, v152
    v_fmac_f32 v154, v112, v147
    v_fmac_f32 v155, v113, v151
    v_fmac_f32 v156, v114, v147
    v_fmac_f32 v157, v115, v151
    v_fmac_f32 v158, v116, v147
    v_fmac_f32 v159, v117, v151
    v_fmac_f32 v160, v118, v147
    v_fmac_f32 v161, v119, v151
    v_fmac_f32 v162, v120, v147
    v_fmac_f32 v163, v121, v151
    v_fmac_f32 v164, v122, v147
    v_fmac_f32 v165, v123, v151
    v_fmac_f32 v166, v124, v147
    v_fmac_f32 v167, v125, v151
    v_fmac_f32 v168, v126, v147
    v_fmac_f32 v169, v127, v151
    v_fmac_f32 v154, v114, v146
    v_fmac_f32 v155, v115, v150
    v_fmac_f32 v156, v116, v146
    v_fmac_f32 v157, v117, v150
    v_fmac_f32 v158, v118, v146
    v_fmac_f32 v159, v119, v150
    v_fmac_f32 v160, v120, v146
    v_fmac_f32 v161, v121, v150
    v_fmac_f32 v162, v122, v146
    v_fmac_f32 v163, v123, v150
    v_fmac_f32 v164, v124, v146
    v_fmac_f32 v165, v125, v150
    v_fmac_f32 v166, v126, v146
    v_fmac_f32 v167, v127, v150
    v_fmac_f32 v168, v128, v146
    v_fmac_f32 v169, v129, v150
    v_mul_f32 v154, v154, v130
    v_mul_f32 v155, v155, v131
    v_mul_f32 v156, v156, v132
    v_mul_f32 v157, v157, v133
    v_mul_f32 v158, v158, v134
    v_mul_f32 v159, v159, v135
    v_mul_f32 v160, v160, v136
    v_mul_f32 v161, v161, v137
    v_mul_f32 v162, v162, v138
    v_mul_f32 v163, v163, v139
    v_mul_f32 v164, v164, v140
    v_mul_f32 v165, v165, v141
    v_mul_f32 v166, v166, v142
    v_mul_f32 v167, v167, v143
    v_mul_f32 v168, v168, v144
    v_mul_f32 v169, v169, v145
    v_cvt_pk_bf16_f32 v170, v168, v166
    v_cvt_pk_bf16_f32 v171, v164, v162
    v_cvt_pk_bf16_f32 v172, v160, v158
    v_cvt_pk_bf16_f32 v173, v156, v154
    v_cvt_pk_bf16_f32 v174, v169, v167
    v_cvt_pk_bf16_f32 v175, v165, v163
    v_cvt_pk_bf16_f32 v176, v161, v159
    v_cvt_pk_bf16_f32 v177, v157, v155
    buffer_store_dwordx4 v[170:173], v9, s[20:23], s35 offen sc1
    v_add_u32 v9, 4096, v9
    buffer_store_dwordx4 v[174:177], v9, s[20:23], s35 offen sc1
    v_add_u32 v9, 4096, v9
    s_nop 1
    v_lshlrev_b32 v108, 16, v18
    v_and_b32 v109, 0xffff0000, v18
    v_lshlrev_b32 v110, 16, v22
    v_and_b32 v111, 0xffff0000, v22
    v_lshlrev_b32 v112, 16, v26
    v_and_b32 v113, 0xffff0000, v26
    v_lshlrev_b32 v114, 16, v30
    v_and_b32 v115, 0xffff0000, v30
    v_lshlrev_b32 v116, 16, v34
    v_and_b32 v117, 0xffff0000, v34
    v_lshlrev_b32 v118, 16, v38
    v_and_b32 v119, 0xffff0000, v38
    v_lshlrev_b32 v120, 16, v42
    v_and_b32 v121, 0xffff0000, v42
    v_lshlrev_b32 v122, 16, v46
    v_and_b32 v123, 0xffff0000, v46
    v_lshlrev_b32 v124, 16, v50
    v_and_b32 v125, 0xffff0000, v50
    v_lshlrev_b32 v126, 16, v54
    v_and_b32 v127, 0xffff0000, v54
    v_lshlrev_b32 v128, 16, v58
    v_and_b32 v129, 0xffff0000, v58
    v_lshlrev_b32 v146, 16, v100
    v_and_b32 v147, 0xffff0000, v100
    v_lshlrev_b32 v148, 16, v101
    v_and_b32 v149, 0xffff0000, v101
    v_lshlrev_b32 v150, 16, v102
    v_and_b32 v151, 0xffff0000, v102
    v_lshlrev_b32 v152, 16, v103
    v_and_b32 v153, 0xffff0000, v103
    v_lshlrev_b32 v130, 16, v62
    v_and_b32 v131, 0xffff0000, v62
    v_lshlrev_b32 v132, 16, v66
    v_and_b32 v133, 0xffff0000, v66
    v_lshlrev_b32 v134, 16, v70
    v_and_b32 v135, 0xffff0000, v70
    v_lshlrev_b32 v136, 16, v74
    v_and_b32 v137, 0xffff0000, v74
    v_lshlrev_b32 v138, 16, v78
    v_and_b32 v139, 0xffff0000, v78
    v_lshlrev_b32 v140, 16, v82
    v_and_b32 v141, 0xffff0000, v82
    v_lshlrev_b32 v142, 16, v86
    v_and_b32 v143, 0xffff0000, v86
    v_lshlrev_b32 v144, 16, v90
    v_and_b32 v145, 0xffff0000, v90
    v_mul_f32 v154, v108, v149
    v_mul_f32 v155, v109, v153
    v_mul_f32 v156, v110, v149
    v_mul_f32 v157, v111, v153
    v_mul_f32 v158, v112, v149
    v_mul_f32 v159, v113, v153
    v_mul_f32 v160, v114, v149
    v_mul_f32 v161, v115, v153
    v_mul_f32 v162, v116, v149
    v_mul_f32 v163, v117, v153
    v_mul_f32 v164, v118, v149
    v_mul_f32 v165, v119, v153
    v_mul_f32 v166, v120, v149
    v_mul_f32 v167, v121, v153
    v_mul_f32 v168, v122, v149
    v_mul_f32 v169, v123, v153
    v_fmac_f32 v154, v110, v148
    v_fmac_f32 v155, v111, v152
    v_fmac_f32 v156, v112, v148
    v_fmac_f32 v157, v113, v152
    v_fmac_f32 v158, v114, v148
    v_fmac_f32 v159, v115, v152
    v_fmac_f32 v160, v116, v148
    v_fmac_f32 v161, v117, v152
    v_fmac_f32 v162, v118, v148
    v_fmac_f32 v163, v119, v152
    v_fmac_f32 v164, v120, v148
    v_fmac_f32 v165, v121, v152
    v_fmac_f32 v166, v122, v148
    v_fmac_f32 v167, v123, v152
    v_fmac_f32 v168, v124, v148
    v_fmac_f32 v169, v125, v152
    v_fmac_f32 v154, v112, v147
    v_fmac_f32 v155, v113, v151
    v_fmac_f32 v156, v114, v147
    v_fmac_f32 v157, v115, v151
    v_fmac_f32 v158, v116, v147
    v_fmac_f32 v159, v117, v151
    v_fmac_f32 v160, v118, v147
    v_fmac_f32 v161, v119, v151
    v_fmac_f32 v162, v120, v147
    v_fmac_f32 v163, v121, v151
    v_fmac_f32 v164, v122, v147
    v_fmac_f32 v165, v123, v151
    v_fmac_f32 v166, v124, v147
    v_fmac_f32 v167, v125, v151
    v_fmac_f32 v168, v126, v147
    v_fmac_f32 v169, v127, v151
    v_fmac_f32 v154, v114, v146
    v_fmac_f32 v155, v115, v150
    v_fmac_f32 v156, v116, v146
    v_fmac_f32 v157, v117, v150
    v_fmac_f32 v158, v118, v146
    v_fmac_f32 v159, v119, v150
    v_fmac_f32 v160, v120, v146
    v_fmac_f32 v161, v121, v150
    v_fmac_f32 v162, v122, v146
    v_fmac_f32 v163, v123, v150
    v_fmac_f32 v164, v124, v146
    v_fmac_f32 v165, v125, v150
    v_fmac_f32 v166, v126, v146
    v_fmac_f32 v167, v127, v150
    v_fmac_f32 v168, v128, v146
    v_fmac_f32 v169, v129, v150
    v_mul_f32 v154, v154, v130
    v_mul_f32 v155, v155, v131
    v_mul_f32 v156, v156, v132
    v_mul_f32 v157, v157, v133
    v_mul_f32 v158, v158, v134
    v_mul_f32 v159, v159, v135
    v_mul_f32 v160, v160, v136
    v_mul_f32 v161, v161, v137
    v_mul_f32 v162, v162, v138
    v_mul_f32 v163, v163, v139
    v_mul_f32 v164, v164, v140
    v_mul_f32 v165, v165, v141
    v_mul_f32 v166, v166, v142
    v_mul_f32 v167, v167, v143
    v_mul_f32 v168, v168, v144
    v_mul_f32 v169, v169, v145
    v_cvt_pk_bf16_f32 v170, v168, v166
    v_cvt_pk_bf16_f32 v171, v164, v162
    v_cvt_pk_bf16_f32 v172, v160, v158
    v_cvt_pk_bf16_f32 v173, v156, v154
    v_cvt_pk_bf16_f32 v174, v169, v167
    v_cvt_pk_bf16_f32 v175, v165, v163
    v_cvt_pk_bf16_f32 v176, v161, v159
    v_cvt_pk_bf16_f32 v177, v157, v155
    buffer_store_dwordx4 v[170:173], v9, s[20:23], s35 offen sc1
    v_add_u32 v9, 4096, v9
    buffer_store_dwordx4 v[174:177], v9, s[20:23], s35 offen sc1
    v_add_u32 v9, 4096, v9
    s_nop 1
    v_lshlrev_b32 v108, 16, v19
    v_and_b32 v109, 0xffff0000, v19
    v_lshlrev_b32 v110, 16, v23
    v_and_b32 v111, 0xffff0000, v23
    v_lshlrev_b32 v112, 16, v27
    v_and_b32 v113, 0xffff0000, v27
    v_lshlrev_b32 v114, 16, v31
    v_and_b32 v115, 0xffff0000, v31
    v_lshlrev_b32 v116, 16, v35
    v_and_b32 v117, 0xffff0000, v35
    v_lshlrev_b32 v118, 16, v39
    v_and_b32 v119, 0xffff0000, v39
    v_lshlrev_b32 v120, 16, v43
    v_and_b32 v121, 0xffff0000, v43
    v_lshlrev_b32 v122, 16, v47
    v_and_b32 v123, 0xffff0000, v47
    v_lshlrev_b32 v124, 16, v51
    v_and_b32 v125, 0xffff0000, v51
    v_lshlrev_b32 v126, 16, v55
    v_and_b32 v127, 0xffff0000, v55
    v_lshlrev_b32 v128, 16, v59
    v_and_b32 v129, 0xffff0000, v59
    v_lshlrev_b32 v146, 16, v104
    v_and_b32 v147, 0xffff0000, v104
    v_lshlrev_b32 v148, 16, v105
    v_and_b32 v149, 0xffff0000, v105
    v_lshlrev_b32 v150, 16, v106
    v_and_b32 v151, 0xffff0000, v106
    v_lshlrev_b32 v152, 16, v107
    v_and_b32 v153, 0xffff0000, v107
    v_lshlrev_b32 v130, 16, v63
    v_and_b32 v131, 0xffff0000, v63
    v_lshlrev_b32 v132, 16, v67
    v_and_b32 v133, 0xffff0000, v67
    v_lshlrev_b32 v134, 16, v71
    v_and_b32 v135, 0xffff0000, v71
    v_lshlrev_b32 v136, 16, v75
    v_and_b32 v137, 0xffff0000, v75
    v_lshlrev_b32 v138, 16, v79
    v_and_b32 v139, 0xffff0000, v79
    v_lshlrev_b32 v140, 16, v83
    v_and_b32 v141, 0xffff0000, v83
    v_lshlrev_b32 v142, 16, v87
    v_and_b32 v143, 0xffff0000, v87
    v_lshlrev_b32 v144, 16, v91
    v_and_b32 v145, 0xffff0000, v91
    v_mul_f32 v154, v108, v149
    v_mul_f32 v155, v109, v153
    v_mul_f32 v156, v110, v149
    v_mul_f32 v157, v111, v153
    v_mul_f32 v158, v112, v149
    v_mul_f32 v159, v113, v153
    v_mul_f32 v160, v114, v149
    v_mul_f32 v161, v115, v153
    v_mul_f32 v162, v116, v149
    v_mul_f32 v163, v117, v153
    v_mul_f32 v164, v118, v149
    v_mul_f32 v165, v119, v153
    v_mul_f32 v166, v120, v149
    v_mul_f32 v167, v121, v153
    v_mul_f32 v168, v122, v149
    v_mul_f32 v169, v123, v153
    v_fmac_f32 v154, v110, v148
    v_fmac_f32 v155, v111, v152
    v_fmac_f32 v156, v112, v148
    v_fmac_f32 v157, v113, v152
    v_fmac_f32 v158, v114, v148
    v_fmac_f32 v159, v115, v152
    v_fmac_f32 v160, v116, v148
    v_fmac_f32 v161, v117, v152
    v_fmac_f32 v162, v118, v148
    v_fmac_f32 v163, v119, v152
    v_fmac_f32 v164, v120, v148
    v_fmac_f32 v165, v121, v152
    v_fmac_f32 v166, v122, v148
    v_fmac_f32 v167, v123, v152
    v_fmac_f32 v168, v124, v148
    v_fmac_f32 v169, v125, v152
    v_fmac_f32 v154, v112, v147
    v_fmac_f32 v155, v113, v151
    v_fmac_f32 v156, v114, v147
    v_fmac_f32 v157, v115, v151
    v_fmac_f32 v158, v116, v147
    v_fmac_f32 v159, v117, v151
    v_fmac_f32 v160, v118, v147
    v_fmac_f32 v161, v119, v151
    v_fmac_f32 v162, v120, v147
    v_fmac_f32 v163, v121, v151
    v_fmac_f32 v164, v122, v147
    v_fmac_f32 v165, v123, v151
    v_fmac_f32 v166, v124, v147
    v_fmac_f32 v167, v125, v151
    v_fmac_f32 v168, v126, v147
    v_fmac_f32 v169, v127, v151
    v_fmac_f32 v154, v114, v146
    v_fmac_f32 v155, v115, v150
    v_fmac_f32 v156, v116, v146
    v_fmac_f32 v157, v117, v150
    v_fmac_f32 v158, v118, v146
    v_fmac_f32 v159, v119, v150
    v_fmac_f32 v160, v120, v146
    v_fmac_f32 v161, v121, v150
    v_fmac_f32 v162, v122, v146
    v_fmac_f32 v163, v123, v150
    v_fmac_f32 v164, v124, v146
    v_fmac_f32 v165, v125, v150
    v_fmac_f32 v166, v126, v146
    v_fmac_f32 v167, v127, v150
    v_fmac_f32 v168, v128, v146
    v_fmac_f32 v169, v129, v150
    v_mul_f32 v154, v154, v130
    v_mul_f32 v155, v155, v131
    v_mul_f32 v156, v156, v132
    v_mul_f32 v157, v157, v133
    v_mul_f32 v158, v158, v134
    v_mul_f32 v159, v159, v135
    v_mul_f32 v160, v160, v136
    v_mul_f32 v161, v161, v137
    v_mul_f32 v162, v162, v138
    v_mul_f32 v163, v163, v139
    v_mul_f32 v164, v164, v140
    v_mul_f32 v165, v165, v141
    v_mul_f32 v166, v166, v142
    v_mul_f32 v167, v167, v143
    v_mul_f32 v168, v168, v144
    v_mul_f32 v169, v169, v145
    v_cvt_pk_bf16_f32 v170, v168, v166
    v_cvt_pk_bf16_f32 v171, v164, v162
    v_cvt_pk_bf16_f32 v172, v160, v158
    v_cvt_pk_bf16_f32 v173, v156, v154
    v_cvt_pk_bf16_f32 v174, v169, v167
    v_cvt_pk_bf16_f32 v175, v165, v163
    v_cvt_pk_bf16_f32 v176, v161, v159
    v_cvt_pk_bf16_f32 v177, v157, v155
    buffer_store_dwordx4 v[170:173], v9, s[20:23], s35 offen sc1
    v_add_u32 v9, 4096, v9
    buffer_store_dwordx4 v[174:177], v9, s[20:23], s35 offen sc1
    v_add_u32 v9, 4096, v9
    s_nop 1
Lssm_hb:
    v_mov_b32 v12, 0
Lssm_npoll:
    buffer_load_dword v14, v12, s[48:51], 0 offen offset:128 sc1
    s_waitcnt vmcnt(0) lgkmcnt(0)
    v_readfirstlane_b32 s64, v14
    s_cmp_lg_u32 s64, 0
    s_cbranch_scc1 Lssm_nok
    s_add_u32 s7, s7, 1
    s_cmp_lt_u32 s7, 0x40000
    s_cbranch_scc1 Lssm_npoll
Lssm_nok:
    v_mov_b32 v232, s64
    s_cmp_lt_u32 s4, 0x7fffffff
    s_cbranch_scc0 Lssm_notileflag
    v_lshlrev_b32 v12, 2, v1
    buffer_store_dword v232, v12, s[20:23], s4 offen sc1
Lssm_notileflag:
    s_mul_i32 s33, s29, 9
    s_add_u32 s33, s33, 8
    s_lshl_b32 s35, s31, 12
    v_lshlrev_b32 v12, 4, v1
    buffer_load_dwordx4 v[184:187], v12, s[40:43], s35 offen offset:0
    buffer_load_dword v188, v12, s[40:43], s35 offen offset:16
    buffer_load_dwordx4 v[192:195], v12, s[40:43], s35 offen offset:1024
    buffer_load_dword v196, v12, s[40:43], s35 offen offset:1040
    buffer_load_dwordx4 v[200:203], v12, s[40:43], s35 offen offset:2048
    buffer_load_dword v204, v12, s[40:43], s35 offen offset:2064
    buffer_load_dwordx4 v[208:211], v12, s[40:43], s35 offen offset:3072
    buffer_load_dword v212, v12, s[40:43], s35 offen offset:3088
    s_lshl_b32 s35, s33, 12
    s_lshl_b32 s36, s28, 9
    s_add_u32 s35, s35, s36
    buffer_load_dwordx4 v[220:223], v12, s[40:43], s35 offen
    buffer_load_dword v224, v12, s[40:43], s35 offen offset:16
    v_mov_b32 v13, 0
    s_lshl_b32 s37, s31, 1
    s_and_b32 s37, s37, 0xfffffffc
    buffer_load_dword v216, v13, s[52:55], s37 offen
    s_lshl_b32 s37, s33, 1
    s_and_b32 s37, s37, 0xfffffffc
    buffer_load_dword v217, v13, s[52:55], s37 offen
    s_waitcnt vmcnt(0)
    s_mul_i32 s32, s28, 12928
    v_mov_b32 v52, 0
    v_mov_b32 v53, 0
    v_mov_b32 v54, 0
    v_mov_b32 v55, 0
    v_lshl_add_u32 v13, v1, 4, s32
    v_lshlrev_b32 v15, 4, v1
    v_cmp_gt_u32 vcc, 32, v1
    s_and_saveexec_b64 s[38:39], vcc
    ds_write_b128 v13, v[52:55] offset:12416
    s_mov_b64 exec, s[38:39]
    v_cmp_gt_u32 vcc, 2, v1
    s_and_saveexec_b64 s[38:39], vcc
    ds_write_b128 v13, v[52:55]
    ds_write_b128 v13, v[52:55] offset:4160
    s_mov_b64 exec, s[38:39]
    s_cmp_eq_u32 s28, 0
    s_cbranch_scc0 Lssm_nopad9
    v_add_u32 v14, 103424, v15
    v_cmp_gt_u32 vcc, 32, v1
    s_and_saveexec_b64 s[38:39], vcc
    ds_write_b128 v14, v[52:55] offset:12416
    s_mov_b64 exec, s[38:39]
    v_cmp_gt_u32 vcc, 2, v1
    s_and_saveexec_b64 s[38:39], vcc
    ds_write_b128 v14, v[52:55]
    ds_write_b128 v14, v[52:55] offset:4160
    s_mov_b64 exec, s[38:39]
Lssm_nopad9:
    s_waitcnt lgkmcnt(0)
    ds_write_b128 v13, v[184:187] offset:32
    v_alignbit_b32 v56, v185, v184, 16
    v_alignbit_b32 v57, v186, v185, 16
    v_alignbit_b32 v58, v187, v186, 16
    v_alignbit_b32 v59, v188, v187, 16
    ds_write_b128 v13, v[56:59] offset:4192
    s_nop 0
    ds_write_b128 v13, v[192:195] offset:1056
    v_alignbit_b32 v56, v193, v192, 16
    v_alignbit_b32 v57, v194, v193, 16
    v_alignbit_b32 v58, v195, v194, 16
    v_alignbit_b32 v59, v196, v195, 16
    ds_write_b128 v13, v[56:59] offset:5216
    s_nop 0
    ds_write_b128 v13, v[200:203] offset:2080
    v_alignbit_b32 v56, v201, v200, 16
    v_alignbit_b32 v57, v202, v201, 16
    v_alignbit_b32 v58, v203, v202, 16
    v_alignbit_b32 v59, v204, v203, 16
    ds_write_b128 v13, v[56:59] offset:6240
    s_nop 0
    ds_write_b128 v13, v[208:211] offset:3104
    v_alignbit_b32 v56, v209, v208, 16
    v_alignbit_b32 v57, v210, v209, 16
    v_alignbit_b32 v58, v211, v210, 16
    v_alignbit_b32 v59, v212, v211, 16
    ds_write_b128 v13, v[56:59] offset:7264
    s_nop 0
    v_lshlrev_b32 v56, 16, v184
    v_cmp_gt_u32 vcc, 1, v1
    s_and_saveexec_b64 s[38:39], vcc
    ds_write_b32 v13, v56 offset:4188
    s_mov_b64 exec, s[38:39]
    s_lshl_b32 s36, s28, 9
    s_add_u32 s36, s36, 103424
    v_add_u32 v14, s36, v15
    v_alignbit_b32 v56, v221, v220, 16
    v_alignbit_b32 v57, v222, v221, 16
    v_alignbit_b32 v58, v223, v222, 16
    v_alignbit_b32 v59, v224, v223, 16
    v_cmp_gt_u32 vcc, 32, v1
    s_and_saveexec_b64 s[38:39], vcc
    ds_write_b128 v14, v[220:223] offset:32
    ds_write_b128 v14, v[56:59] offset:4192
    s_mov_b64 exec, s[38:39]
    s_cmp_eq_u32 s28, 0
    s_cbranch_scc0 Lssm_nosp9
    v_lshlrev_b32 v56, 16, v220
    v_cmp_gt_u32 vcc, 1, v1
    s_and_saveexec_b64 s[38:39], vcc
    ds_write_b32 v14, v56 offset:4188
    s_mov_b64 exec, s[38:39]
Lssm_nosp9:
    v_readfirstlane_b32 s33, v216
    v_readfirstlane_b32 s34, v217
    s_bitcmp1_b32 s31, 0
    s_cselect_b32 s37, 0, 16
    s_lshl_b32 s33, s33, s37
    s_and_b32 s33, s33, 0xffff0000
    s_bitcmp1_b32 s29, 0
    s_cselect_b32 s37, 0, 16
    s_lshl_b32 s34, s34, s37
    s_and_b32 s34, s34, 0xffff0000
    s_waitcnt lgkmcnt(0)
    s_cmp_eq_u32 s28, 0
    s_cbranch_scc0 Lssm_w1_bar
    s_mul_i32 s36, s29, 9
    s_lshr_b32 s37, s36, 6
    s_add_u32 s36, s36, 8
    s_lshr_b32 s36, s36, 6
    v_and_b32 v12, 31, v1
    v_lshlrev_b32 v12, 8, v12
    s_lshl_b32 s37, s37, 13
    s_lshl_b32 s36, s36, 13
    v_mov_b32 v14, s37
    v_mov_b32 v16, s36
    v_cmp_gt_u32 vcc, 32, v1
    s_nop 1
    v_cndmask_b32 v14, v16, v14, vcc
    v_add_u32 v12, v12, v14
    s_mov_b32 s36, 33480704
Lssm_w1_poll:
    buffer_load_dword v14, v12, s[20:23], s36 offen sc1
    s_waitcnt vmcnt(0)
    v_cmp_eq_u32 vcc, s64, v14
    s_nop 1
    s_cmp_eq_u64 vcc, -1
    s_cbranch_scc1 Lssm_w1_bar
    s_sleep 8
    s_add_u32 s7, s7, 1
    s_cmp_lt_u32 s7, 0x40000
    s_cbranch_scc1 Lssm_w1_poll
Lssm_w1_bar:
    s_barrier
    s_lshl_b32 s35, s31, 12
    s_add_u32 s35, s35, 28311552
    v_lshlrev_b32 v12, 4, v1
    buffer_load_dwordx4 v[16:19], v12, s[20:23], s35 offen offset:0 sc1
    buffer_load_dwordx4 v[20:23], v12, s[20:23], s35 offen offset:1024 sc1
    buffer_load_dwordx4 v[24:27], v12, s[20:23], s35 offen offset:2048 sc1
    buffer_load_dwordx4 v[28:31], v12, s[20:23], s35 offen offset:3072 sc1
    s_mul_i32 s36, s29, 9
    s_add_u32 s36, s36, 8
    s_lshl_b32 s36, s36, 12
    s_lshl_b32 s37, s28, 9
    s_add_u32 s36, s36, s37
    s_add_u32 s36, s36, 28311552
    buffer_load_dwordx4 v[32:35], v12, s[20:23], s36 offen sc1
    v_and_b32 v2, 15, v1
    v_lshrrev_b32 v3, 4, v1
    v_add_u32 v12, 1, v2
    v_lshrrev_b32 v12, 1, v12
    v_lshlrev_b32 v12, 2, v12
    v_lshl_add_u32 v12, v3, 4, v12
    v_and_b32 v14, 1, v2
    v_xor_b32 v14, 1, v14
    v_mul_u32_u24 v14, 4160, v14
    v_add_u32 v11, v12, v14
    v_add_u32 v4, 0, v11
    v_add_u32 v4, s32, v4
    v_add_u32 v5, 1024, v11
    v_add_u32 v5, s32, v5
    v_add_u32 v6, 2048, v11
    v_add_u32 v6, s32, v6
    v_add_u32 v7, 3072, v11
    v_add_u32 v7, s32, v7
    v_lshlrev_b32 v12, 5, v2
    v_lshlrev_b32 v14, 4, v3
    v_sub_u32 v60, v14, v12
    s_add_u32 s37, s32, 8800
    v_add_u32 v8, s37, v60
    v_lshlrev_b32 v14, 3, v3
    v_add_u32 v10, v14, v12
    s_add_u32 s37, s32, 8824
    v_sub_u32 v9, s37, v10
    s_waitcnt vmcnt(0)
    ds_write_b128 v13, v[16:19] offset:8320
    ds_write_b128 v13, v[20:23] offset:9344
    ds_write_b128 v13, v[24:27] offset:10368
    ds_write_b128 v13, v[28:31] offset:11392
    s_lshl_b32 s36, s28, 9
    s_add_u32 s36, s36, 111744
    v_add_u32 v14, s36, v15
    v_cmp_gt_u32 vcc, 32, v1
    s_and_saveexec_b64 s[38:39], vcc
    ds_write_b128 v14, v[32:35]
    s_mov_b64 exec, s[38:39]
    s_waitcnt lgkmcnt(0)
    s_barrier
    s_lshl_b32 s36, s28, 6
    s_add_u32 s37, s36, 103424
    v_add_u32 v48, 0, v11
    v_add_u32 v48, s37, v48
    v_add_u32 v49, 1024, v11
    v_add_u32 v49, s37, v49
    v_add_u32 v50, 2048, v11
    v_add_u32 v50, s37, v50
    v_add_u32 v51, 3072, v11
    v_add_u32 v51, s37, v51
    s_add_u32 s37, s37, 8800
    v_add_u32 v52, s37, v60
    ds_read_b128 v[128:131], v8 offset:3584
    ds_read2_b32 v[64:65], v4 offset0:0 offset1:1
    ds_read2_b32 v[66:67], v4 offset0:2 offset1:3
    ds_read_b128 v[132:135], v8 offset:3072
    ds_read2_b32 v[68:69], v4 offset0:128 offset1:129
    ds_read2_b32 v[70:71], v4 offset0:130 offset1:131
    ds_read_b128 v[136:139], v8 offset:2560
    ds_read2_b32 v[72:73], v5 offset0:0 offset1:1
    ds_read2_b32 v[74:75], v5 offset0:2 offset1:3
    ds_read_b128 v[140:143], v8 offset:2048
    ds_read2_b32 v[76:77], v5 offset0:128 offset1:129
    ds_read2_b32 v[78:79], v5 offset0:130 offset1:131
    ds_read_b128 v[144:147], v8 offset:1536
    ds_read2_b32 v[80:81], v6 offset0:0 offset1:1
    ds_read2_b32 v[82:83], v6 offset0:2 offset1:3
    s_waitcnt lgkmcnt(14)
    ds_read_b128 v[148:151], v8 offset:1024
    s_waitcnt lgkmcnt(14)
    ds_read2_b32 v[84:85], v6 offset0:128 offset1:129
    s_waitcnt lgkmcnt(14)
    ds_read2_b32 v[86:87], v6 offset0:130 offset1:131
    s_waitcnt lgkmcnt(14)
    ds_read_b128 v[152:155], v8 offset:512
    s_waitcnt lgkmcnt(14)
    ds_read2_b32 v[88:89], v7 offset0:0 offset1:1
    s_waitcnt lgkmcnt(14)
    ds_read2_b32 v[90:91], v7 offset0:2 offset1:3
    s_waitcnt lgkmcnt(14)
    ds_read_b128 v[156:159], v8 offset:0
    s_waitcnt lgkmcnt(14)
    ds_read2_b32 v[92:93], v7 offset0:128 offset1:129
    s_waitcnt lgkmcnt(14)
    ds_read2_b32 v[94:95], v7 offset0:130 offset1:131
    s_setprio 3
    v_mfma_f32_16x16x32_bf16 v[16:19], v[64:67], v[128:131], 0
    v_mfma_f32_16x16x32_bf16 v[20:23], v[64:67], v[132:135], 0
    v_mfma_f32_16x16x32_bf16 v[24:27], v[64:67], v[136:139], 0
    s_waitcnt lgkmcnt(14)
    v_mfma_f32_16x16x32_bf16 v[28:31], v[64:67], v[140:143], 0
    s_waitcnt lgkmcnt(11)
    v_mfma_f32_16x16x32_bf16 v[32:35], v[64:67], v[144:147], 0
    s_waitcnt lgkmcnt(8)
    v_mfma_f32_16x16x32_bf16 v[36:39], v[64:67], v[148:151], 0
    ds_read_b128 v[160:163], v8 offset:3648
    s_waitcnt lgkmcnt(6)
    v_mfma_f32_16x16x32_bf16 v[40:43], v[64:67], v[152:155], 0
    ds_read2_b32 v[96:97], v4 offset0:16 offset1:17
    s_waitcnt lgkmcnt(4)
    v_mfma_f32_16x16x32_bf16 v[44:47], v[64:67], v[156:159], 0
    ds_read2_b32 v[98:99], v4 offset0:18 offset1:19
    v_mfma_f32_16x16x32_bf16 v[20:23], v[68:71], v[128:131], v[20:23]
    ds_read_b128 v[164:167], v8 offset:3136
    v_mfma_f32_16x16x32_bf16 v[24:27], v[68:71], v[132:135], v[24:27]
    ds_read2_b32 v[100:101], v4 offset0:144 offset1:145
    v_mfma_f32_16x16x32_bf16 v[28:31], v[68:71], v[136:139], v[28:31]
    ds_read2_b32 v[102:103], v4 offset0:146 offset1:147
    v_mfma_f32_16x16x32_bf16 v[32:35], v[68:71], v[140:143], v[32:35]
    ds_read_b128 v[168:171], v8 offset:2624
    v_mfma_f32_16x16x32_bf16 v[36:39], v[68:71], v[144:147], v[36:39]
    ds_read2_b32 v[104:105], v5 offset0:16 offset1:17
    v_mfma_f32_16x16x32_bf16 v[40:43], v[68:71], v[148:151], v[40:43]
    ds_read2_b32 v[106:107], v5 offset0:18 offset1:19
    v_mfma_f32_16x16x32_bf16 v[44:47], v[68:71], v[152:155], v[44:47]
    ds_read_b128 v[172:175], v8 offset:2112
    v_mfma_f32_16x16x32_bf16 v[24:27], v[72:75], v[128:131], v[24:27]
    ds_read2_b32 v[108:109], v5 offset0:144 offset1:145
    v_mfma_f32_16x16x32_bf16 v[28:31], v[72:75], v[132:135], v[28:31]
    ds_read2_b32 v[110:111], v5 offset0:146 offset1:147
    v_mfma_f32_16x16x32_bf16 v[32:35], v[72:75], v[136:139], v[32:35]
    ds_read_b128 v[176:179], v8 offset:1600
    v_mfma_f32_16x16x32_bf16 v[36:39], v[72:75], v[140:143], v[36:39]
    s_waitcnt lgkmcnt(14)
    ds_read2_b32 v[112:113], v6 offset0:16 offset1:17
    v_mfma_f32_16x16x32_bf16 v[40:43], v[72:75], v[144:147], v[40:43]
    s_waitcnt lgkmcnt(14)
    ds_read2_b32 v[114:115], v6 offset0:18 offset1:19
    v_mfma_f32_16x16x32_bf16 v[44:47], v[72:75], v[148:151], v[44:47]
    s_waitcnt lgkmcnt(14)
    ds_read_b128 v[180:183], v8 offset:1088
    v_mfma_f32_16x16x32_bf16 v[28:31], v[76:79], v[128:131], v[28:31]
    s_waitcnt lgkmcnt(14)
    ds_read2_b32 v[116:117], v6 offset0:144 offset1:145
    v_mfma_f32_16x16x32_bf16 v[32:35], v[76:79], v[132:135], v[32:35]
    s_waitcnt lgkmcnt(14)
    ds_read2_b32 v[118:119], v6 offset0:146 offset1:147
    v_mfma_f32_16x16x32_bf16 v[36:39], v[76:79], v[136:139], v[36:39]
    s_waitcnt lgkmcnt(14)
    ds_read_b128 v[184:187], v8 offset:576
    v_mfma_f32_16x16x32_bf16 v[40:43], v[76:79], v[140:143], v[40:43]
    s_waitcnt lgkmcnt(14)
    ds_read2_b32 v[120:121], v7 offset0:16 offset1:17
    v_mfma_f32_16x16x32_bf16 v[44:47], v[76:79], v[144:147], v[44:47]
    s_waitcnt lgkmcnt(14)
    ds_read2_b32 v[122:123], v7 offset0:18 offset1:19
    v_mfma_f32_16x16x32_bf16 v[32:35], v[80:83], v[128:131], v[32:35]
    s_waitcnt lgkmcnt(14)
    ds_read_b128 v[188:191], v8 offset:64
    v_mfma_f32_16x16x32_bf16 v[36:39], v[80:83], v[132:135], v[36:39]
    s_waitcnt lgkmcnt(14)
    ds_read2_b32 v[124:125], v7 offset0:144 offset1:145
    v_mfma_f32_16x16x32_bf16 v[40:43], v[80:83], v[136:139], v[40:43]
    s_waitcnt lgkmcnt(14)
    ds_read2_b32 v[126:127], v7 offset0:146 offset1:147
    v_mfma_f32_16x16x32_bf16 v[44:47], v[80:83], v[140:143], v[44:47]
    v_mfma_f32_16x16x32_bf16 v[36:39], v[84:87], v[128:131], v[36:39]
    v_mfma_f32_16x16x32_bf16 v[40:43], v[84:87], v[132:135], v[40:43]
    v_mfma_f32_16x16x32_bf16 v[44:47], v[84:87], v[136:139], v[44:47]
    v_mfma_f32_16x16x32_bf16 v[40:43], v[88:91], v[128:131], v[40:43]
    v_mfma_f32_16x16x32_bf16 v[44:47], v[88:91], v[132:135], v[44:47]
    v_mfma_f32_16x16x32_bf16 v[44:47], v[92:95], v[128:131], v[44:47]
    v_mfma_f32_16x16x32_bf16 v[16:19], v[96:99], v[160:163], v[16:19]
    v_mfma_f32_16x16x32_bf16 v[20:23], v[96:99], v[164:167], v[20:23]
    v_mfma_f32_16x16x32_bf16 v[24:27], v[96:99], v[168:171], v[24:27]
    s_waitcnt lgkmcnt(14)
    v_mfma_f32_16x16x32_bf16 v[28:31], v[96:99], v[172:175], v[28:31]
    s_waitcnt lgkmcnt(11)
    v_mfma_f32_16x16x32_bf16 v[32:35], v[96:99], v[176:179], v[32:35]
    s_waitcnt lgkmcnt(8)
    v_mfma_f32_16x16x32_bf16 v[36:39], v[96:99], v[180:183], v[36:39]
    ds_read_b128 v[128:131], v8 offset:3712
    s_waitcnt lgkmcnt(6)
    v_mfma_f32_16x16x32_bf16 v[40:43], v[96:99], v[184:187], v[40:43]
    ds_read2_b32 v[64:65], v4 offset0:32 offset1:33
    s_waitcnt lgkmcnt(4)
    v_mfma_f32_16x16x32_bf16 v[44:47], v[96:99], v[188:191], v[44:47]
    ds_read2_b32 v[66:67], v4 offset0:34 offset1:35
    v_mfma_f32_16x16x32_bf16 v[20:23], v[100:103], v[160:163], v[20:23]
    ds_read_b128 v[132:135], v8 offset:3200
    v_mfma_f32_16x16x32_bf16 v[24:27], v[100:103], v[164:167], v[24:27]
    ds_read2_b32 v[68:69], v4 offset0:160 offset1:161
    v_mfma_f32_16x16x32_bf16 v[28:31], v[100:103], v[168:171], v[28:31]
    ds_read2_b32 v[70:71], v4 offset0:162 offset1:163
    v_mfma_f32_16x16x32_bf16 v[32:35], v[100:103], v[172:175], v[32:35]
    ds_read_b128 v[136:139], v8 offset:2688
    v_mfma_f32_16x16x32_bf16 v[36:39], v[100:103], v[176:179], v[36:39]
    ds_read2_b32 v[72:73], v5 offset0:32 offset1:33
    v_mfma_f32_16x16x32_bf16 v[40:43], v[100:103], v[180:183], v[40:43]
    ds_read2_b32 v[74:75], v5 offset0:34 offset1:35
    v_mfma_f32_16x16x32_bf16 v[44:47], v[100:103], v[184:187], v[44:47]
    ds_read_b128 v[140:143], v8 offset:2176
    v_mfma_f32_16x16x32_bf16 v[24:27], v[104:107], v[160:163], v[24:27]
    ds_read2_b32 v[76:77], v5 offset0:160 offset1:161
    v_mfma_f32_16x16x32_bf16 v[28:31], v[104:107], v[164:167], v[28:31]
    ds_read2_b32 v[78:79], v5 offset0:162 offset1:163
    v_mfma_f32_16x16x32_bf16 v[32:35], v[104:107], v[168:171], v[32:35]
    ds_read_b128 v[144:147], v8 offset:1664
    v_mfma_f32_16x16x32_bf16 v[36:39], v[104:107], v[172:175], v[36:39]
    s_waitcnt lgkmcnt(14)
    ds_read2_b32 v[80:81], v6 offset0:32 offset1:33
    v_mfma_f32_16x16x32_bf16 v[40:43], v[104:107], v[176:179], v[40:43]
    s_waitcnt lgkmcnt(14)
    ds_read2_b32 v[82:83], v6 offset0:34 offset1:35
    v_mfma_f32_16x16x32_bf16 v[44:47], v[104:107], v[180:183], v[44:47]
    s_waitcnt lgkmcnt(14)
    ds_read_b128 v[148:151], v8 offset:1152
    v_mfma_f32_16x16x32_bf16 v[28:31], v[108:111], v[160:163], v[28:31]
    s_waitcnt lgkmcnt(14)
    ds_read2_b32 v[84:85], v6 offset0:160 offset1:161
    v_mfma_f32_16x16x32_bf16 v[32:35], v[108:111], v[164:167], v[32:35]
    s_waitcnt lgkmcnt(14)
    ds_read2_b32 v[86:87], v6 offset0:162 offset1:163
    v_mfma_f32_16x16x32_bf16 v[36:39], v[108:111], v[168:171], v[36:39]
    s_waitcnt lgkmcnt(14)
    ds_read_b128 v[152:155], v8 offset:640
    v_mfma_f32_16x16x32_bf16 v[40:43], v[108:111], v[172:175], v[40:43]
    s_waitcnt lgkmcnt(14)
    ds_read2_b32 v[88:89], v7 offset0:32 offset1:33
    v_mfma_f32_16x16x32_bf16 v[44:47], v[108:111], v[176:179], v[44:47]
    s_waitcnt lgkmcnt(14)
    ds_read2_b32 v[90:91], v7 offset0:34 offset1:35
    v_mfma_f32_16x16x32_bf16 v[32:35], v[112:115], v[160:163], v[32:35]
    s_waitcnt lgkmcnt(14)
    ds_read_b128 v[156:159], v8 offset:128
    v_mfma_f32_16x16x32_bf16 v[36:39], v[112:115], v[164:167], v[36:39]
    s_waitcnt lgkmcnt(14)
    ds_read2_b32 v[92:93], v7 offset0:160 offset1:161
    v_mfma_f32_16x16x32_bf16 v[40:43], v[112:115], v[168:171], v[40:43]
    s_waitcnt lgkmcnt(14)
    ds_read2_b32 v[94:95], v7 offset0:162 offset1:163
    v_mfma_f32_16x16x32_bf16 v[44:47], v[112:115], v[172:175], v[44:47]
    v_mfma_f32_16x16x32_bf16 v[36:39], v[116:119], v[160:163], v[36:39]
    v_mfma_f32_16x16x32_bf16 v[40:43], v[116:119], v[164:167], v[40:43]
    v_mfma_f32_16x16x32_bf16 v[44:47], v[116:119], v[168:171], v[44:47]
    v_mfma_f32_16x16x32_bf16 v[40:43], v[120:123], v[160:163], v[40:43]
    v_mfma_f32_16x16x32_bf16 v[44:47], v[120:123], v[164:167], v[44:47]
    v_mfma_f32_16x16x32_bf16 v[44:47], v[124:127], v[160:163], v[44:47]
    s_setprio 2
    v_mfma_f32_16x16x32_bf16 v[16:19], v[64:67], v[128:131], v[16:19]
    v_mfma_f32_16x16x32_bf16 v[20:23], v[64:67], v[132:135], v[20:23]
    v_mfma_f32_16x16x32_bf16 v[24:27], v[64:67], v[136:139], v[24:27]
    s_waitcnt lgkmcnt(14)
    v_mfma_f32_16x16x32_bf16 v[28:31], v[64:67], v[140:143], v[28:31]
    s_waitcnt lgkmcnt(11)
    v_mfma_f32_16x16x32_bf16 v[32:35], v[64:67], v[144:147], v[32:35]
    s_waitcnt lgkmcnt(8)
    v_mfma_f32_16x16x32_bf16 v[36:39], v[64:67], v[148:151], v[36:39]
    ds_read_b128 v[160:163], v8 offset:3776
    s_waitcnt lgkmcnt(6)
    v_mfma_f32_16x16x32_bf16 v[40:43], v[64:67], v[152:155], v[40:43]
    ds_read2_b32 v[96:97], v4 offset0:48 offset1:49
    s_waitcnt lgkmcnt(4)
    v_mfma_f32_16x16x32_bf16 v[44:47], v[64:67], v[156:159], v[44:47]
    ds_read2_b32 v[98:99], v4 offset0:50 offset1:51
    v_mfma_f32_16x16x32_bf16 v[20:23], v[68:71], v[128:131], v[20:23]
    ds_read_b128 v[164:167], v8 offset:3264
    v_mfma_f32_16x16x32_bf16 v[24:27], v[68:71], v[132:135], v[24:27]
    ds_read2_b32 v[100:101], v4 offset0:176 offset1:177
    v_mfma_f32_16x16x32_bf16 v[28:31], v[68:71], v[136:139], v[28:31]
    ds_read2_b32 v[102:103], v4 offset0:178 offset1:179
    v_mfma_f32_16x16x32_bf16 v[32:35], v[68:71], v[140:143], v[32:35]
    ds_read_b128 v[168:171], v8 offset:2752
    v_mfma_f32_16x16x32_bf16 v[36:39], v[68:71], v[144:147], v[36:39]
    ds_read2_b32 v[104:105], v5 offset0:48 offset1:49
    v_mfma_f32_16x16x32_bf16 v[40:43], v[68:71], v[148:151], v[40:43]
    ds_read2_b32 v[106:107], v5 offset0:50 offset1:51
    v_mfma_f32_16x16x32_bf16 v[44:47], v[68:71], v[152:155], v[44:47]
    ds_read_b128 v[172:175], v8 offset:2240
    v_mfma_f32_16x16x32_bf16 v[24:27], v[72:75], v[128:131], v[24:27]
    ds_read2_b32 v[108:109], v5 offset0:176 offset1:177
    v_mfma_f32_16x16x32_bf16 v[28:31], v[72:75], v[132:135], v[28:31]
    ds_read2_b32 v[110:111], v5 offset0:178 offset1:179
    v_mfma_f32_16x16x32_bf16 v[32:35], v[72:75], v[136:139], v[32:35]
    ds_read_b128 v[176:179], v8 offset:1728
    v_mfma_f32_16x16x32_bf16 v[36:39], v[72:75], v[140:143], v[36:39]
    s_waitcnt lgkmcnt(14)
    ds_read2_b32 v[112:113], v6 offset0:48 offset1:49
    v_mfma_f32_16x16x32_bf16 v[40:43], v[72:75], v[144:147], v[40:43]
    s_waitcnt lgkmcnt(14)
    ds_read2_b32 v[114:115], v6 offset0:50 offset1:51
    v_mfma_f32_16x16x32_bf16 v[44:47], v[72:75], v[148:151], v[44:47]
    s_waitcnt lgkmcnt(14)
    ds_read_b128 v[180:183], v8 offset:1216
    v_mfma_f32_16x16x32_bf16 v[28:31], v[76:79], v[128:131], v[28:31]
    s_waitcnt lgkmcnt(14)
    ds_read2_b32 v[116:117], v6 offset0:176 offset1:177
    v_mfma_f32_16x16x32_bf16 v[32:35], v[76:79], v[132:135], v[32:35]
    s_waitcnt lgkmcnt(14)
    ds_read2_b32 v[118:119], v6 offset0:178 offset1:179
    v_mfma_f32_16x16x32_bf16 v[36:39], v[76:79], v[136:139], v[36:39]
    s_waitcnt lgkmcnt(14)
    ds_read_b128 v[184:187], v8 offset:704
    v_mfma_f32_16x16x32_bf16 v[40:43], v[76:79], v[140:143], v[40:43]
    s_waitcnt lgkmcnt(14)
    ds_read2_b32 v[120:121], v7 offset0:48 offset1:49
    v_mfma_f32_16x16x32_bf16 v[44:47], v[76:79], v[144:147], v[44:47]
    s_waitcnt lgkmcnt(14)
    ds_read2_b32 v[122:123], v7 offset0:50 offset1:51
    v_mfma_f32_16x16x32_bf16 v[32:35], v[80:83], v[128:131], v[32:35]
    s_waitcnt lgkmcnt(14)
    ds_read_b128 v[188:191], v8 offset:192
    v_mfma_f32_16x16x32_bf16 v[36:39], v[80:83], v[132:135], v[36:39]
    s_waitcnt lgkmcnt(14)
    ds_read2_b32 v[124:125], v7 offset0:176 offset1:177
    v_mfma_f32_16x16x32_bf16 v[40:43], v[80:83], v[136:139], v[40:43]
    s_waitcnt lgkmcnt(14)
    ds_read2_b32 v[126:127], v7 offset0:178 offset1:179
    v_mfma_f32_16x16x32_bf16 v[44:47], v[80:83], v[140:143], v[44:47]
    v_mfma_f32_16x16x32_bf16 v[36:39], v[84:87], v[128:131], v[36:39]
    v_mfma_f32_16x16x32_bf16 v[40:43], v[84:87], v[132:135], v[40:43]
    v_mfma_f32_16x16x32_bf16 v[44:47], v[84:87], v[136:139], v[44:47]
    v_mfma_f32_16x16x32_bf16 v[40:43], v[88:91], v[128:131], v[40:43]
    v_mfma_f32_16x16x32_bf16 v[44:47], v[88:91], v[132:135], v[44:47]
    v_mfma_f32_16x16x32_bf16 v[44:47], v[92:95], v[128:131], v[44:47]
    v_mfma_f32_16x16x32_bf16 v[16:19], v[96:99], v[160:163], v[16:19]
    v_mfma_f32_16x16x32_bf16 v[20:23], v[96:99], v[164:167], v[20:23]
    v_mfma_f32_16x16x32_bf16 v[24:27], v[96:99], v[168:171], v[24:27]
    s_waitcnt lgkmcnt(14)
    v_mfma_f32_16x16x32_bf16 v[28:31], v[96:99], v[172:175], v[28:31]
    s_waitcnt lgkmcnt(11)
    v_mfma_f32_16x16x32_bf16 v[32:35], v[96:99], v[176:179], v[32:35]
    s_waitcnt lgkmcnt(8)
    v_mfma_f32_16x16x32_bf16 v[36:39], v[96:99], v[180:183], v[36:39]
    ds_read_b128 v[128:131], v8 offset:3840
    s_waitcnt lgkmcnt(6)
    v_mfma_f32_16x16x32_bf16 v[40:43], v[96:99], v[184:187], v[40:43]
    ds_read2_b32 v[64:65], v4 offset0:64 offset1:65
    s_waitcnt lgkmcnt(4)
    v_mfma_f32_16x16x32_bf16 v[44:47], v[96:99], v[188:191], v[44:47]
    ds_read2_b32 v[66:67], v4 offset0:66 offset1:67
    v_mfma_f32_16x16x32_bf16 v[20:23], v[100:103], v[160:163], v[20:23]
    ds_read_b128 v[132:135], v8 offset:3328
    v_mfma_f32_16x16x32_bf16 v[24:27], v[100:103], v[164:167], v[24:27]
    ds_read2_b32 v[68:69], v4 offset0:192 offset1:193
    v_mfma_f32_16x16x32_bf16 v[28:31], v[100:103], v[168:171], v[28:31]
    ds_read2_b32 v[70:71], v4 offset0:194 offset1:195
    v_mfma_f32_16x16x32_bf16 v[32:35], v[100:103], v[172:175], v[32:35]
    ds_read_b128 v[136:139], v8 offset:2816
    v_mfma_f32_16x16x32_bf16 v[36:39], v[100:103], v[176:179], v[36:39]
    ds_read2_b32 v[72:73], v5 offset0:64 offset1:65
    v_mfma_f32_16x16x32_bf16 v[40:43], v[100:103], v[180:183], v[40:43]
    ds_read2_b32 v[74:75], v5 offset0:66 offset1:67
    v_mfma_f32_16x16x32_bf16 v[44:47], v[100:103], v[184:187], v[44:47]
    ds_read_b128 v[140:143], v8 offset:2304
    v_mfma_f32_16x16x32_bf16 v[24:27], v[104:107], v[160:163], v[24:27]
    ds_read2_b32 v[76:77], v5 offset0:192 offset1:193
    v_mfma_f32_16x16x32_bf16 v[28:31], v[104:107], v[164:167], v[28:31]
    ds_read2_b32 v[78:79], v5 offset0:194 offset1:195
    v_mfma_f32_16x16x32_bf16 v[32:35], v[104:107], v[168:171], v[32:35]
    ds_read_b128 v[144:147], v8 offset:1792
    v_mfma_f32_16x16x32_bf16 v[36:39], v[104:107], v[172:175], v[36:39]
    s_waitcnt lgkmcnt(14)
    ds_read2_b32 v[80:81], v6 offset0:64 offset1:65
    v_mfma_f32_16x16x32_bf16 v[40:43], v[104:107], v[176:179], v[40:43]
    s_waitcnt lgkmcnt(14)
    ds_read2_b32 v[82:83], v6 offset0:66 offset1:67
    v_mfma_f32_16x16x32_bf16 v[44:47], v[104:107], v[180:183], v[44:47]
    s_waitcnt lgkmcnt(14)
    ds_read_b128 v[148:151], v8 offset:1280
    v_mfma_f32_16x16x32_bf16 v[28:31], v[108:111], v[160:163], v[28:31]
    s_waitcnt lgkmcnt(14)
    ds_read2_b32 v[84:85], v6 offset0:192 offset1:193
    v_mfma_f32_16x16x32_bf16 v[32:35], v[108:111], v[164:167], v[32:35]
    s_waitcnt lgkmcnt(14)
    ds_read2_b32 v[86:87], v6 offset0:194 offset1:195
    v_mfma_f32_16x16x32_bf16 v[36:39], v[108:111], v[168:171], v[36:39]
    s_waitcnt lgkmcnt(14)
    ds_read_b128 v[152:155], v8 offset:768
    v_mfma_f32_16x16x32_bf16 v[40:43], v[108:111], v[172:175], v[40:43]
    s_waitcnt lgkmcnt(14)
    ds_read2_b32 v[88:89], v7 offset0:64 offset1:65
    v_mfma_f32_16x16x32_bf16 v[44:47], v[108:111], v[176:179], v[44:47]
    s_waitcnt lgkmcnt(14)
    ds_read2_b32 v[90:91], v7 offset0:66 offset1:67
    v_mfma_f32_16x16x32_bf16 v[32:35], v[112:115], v[160:163], v[32:35]
    s_waitcnt lgkmcnt(14)
    ds_read_b128 v[156:159], v8 offset:256
    v_mfma_f32_16x16x32_bf16 v[36:39], v[112:115], v[164:167], v[36:39]
    s_waitcnt lgkmcnt(14)
    ds_read2_b32 v[92:93], v7 offset0:192 offset1:193
    v_mfma_f32_16x16x32_bf16 v[40:43], v[112:115], v[168:171], v[40:43]
    s_waitcnt lgkmcnt(14)
    ds_read2_b32 v[94:95], v7 offset0:194 offset1:195
    v_mfma_f32_16x16x32_bf16 v[44:47], v[112:115], v[172:175], v[44:47]
    v_mfma_f32_16x16x32_bf16 v[36:39], v[116:119], v[160:163], v[36:39]
    v_mfma_f32_16x16x32_bf16 v[40:43], v[116:119], v[164:167], v[40:43]
    v_mfma_f32_16x16x32_bf16 v[44:47], v[116:119], v[168:171], v[44:47]
    v_mfma_f32_16x16x32_bf16 v[40:43], v[120:123], v[160:163], v[40:43]
    v_mfma_f32_16x16x32_bf16 v[44:47], v[120:123], v[164:167], v[44:47]
    v_mfma_f32_16x16x32_bf16 v[44:47], v[124:127], v[160:163], v[44:47]
    s_setprio 1
    v_mfma_f32_16x16x32_bf16 v[16:19], v[64:67], v[128:131], v[16:19]
    v_mfma_f32_16x16x32_bf16 v[20:23], v[64:67], v[132:135], v[20:23]
    v_mfma_f32_16x16x32_bf16 v[24:27], v[64:67], v[136:139], v[24:27]
    s_waitcnt lgkmcnt(14)
    v_mfma_f32_16x16x32_bf16 v[28:31], v[64:67], v[140:143], v[28:31]
    s_waitcnt lgkmcnt(11)
    v_mfma_f32_16x16x32_bf16 v[32:35], v[64:67], v[144:147], v[32:35]
    s_waitcnt lgkmcnt(8)
    v_mfma_f32_16x16x32_bf16 v[36:39], v[64:67], v[148:151], v[36:39]
    ds_read_b128 v[160:163], v8 offset:3904
    s_waitcnt lgkmcnt(6)
    v_mfma_f32_16x16x32_bf16 v[40:43], v[64:67], v[152:155], v[40:43]
    ds_read2_b32 v[96:97], v4 offset0:80 offset1:81
    s_waitcnt lgkmcnt(4)
    v_mfma_f32_16x16x32_bf16 v[44:47], v[64:67], v[156:159], v[44:47]
    ds_read2_b32 v[98:99], v4 offset0:82 offset1:83
    v_mfma_f32_16x16x32_bf16 v[20:23], v[68:71], v[128:131], v[20:23]
    ds_read_b128 v[164:167], v8 offset:3392
    v_mfma_f32_16x16x32_bf16 v[24:27], v[68:71], v[132:135], v[24:27]
    ds_read2_b32 v[100:101], v4 offset0:208 offset1:209
    v_mfma_f32_16x16x32_bf16 v[28:31], v[68:71], v[136:139], v[28:31]
    ds_read2_b32 v[102:103], v4 offset0:210 offset1:211
    v_mfma_f32_16x16x32_bf16 v[32:35], v[68:71], v[140:143], v[32:35]
    ds_read_b128 v[168:171], v8 offset:2880
    v_mfma_f32_16x16x32_bf16 v[36:39], v[68:71], v[144:147], v[36:39]
    ds_read2_b32 v[104:105], v5 offset0:80 offset1:81
    v_mfma_f32_16x16x32_bf16 v[40:43], v[68:71], v[148:151], v[40:43]
    ds_read2_b32 v[106:107], v5 offset0:82 offset1:83
    v_mfma_f32_16x16x32_bf16 v[44:47], v[68:71], v[152:155], v[44:47]
    ds_read_b128 v[172:175], v8 offset:2368
    v_mfma_f32_16x16x32_bf16 v[24:27], v[72:75], v[128:131], v[24:27]
    ds_read2_b32 v[108:109], v5 offset0:208 offset1:209
    v_mfma_f32_16x16x32_bf16 v[28:31], v[72:75], v[132:135], v[28:31]
    ds_read2_b32 v[110:111], v5 offset0:210 offset1:211
    v_mfma_f32_16x16x32_bf16 v[32:35], v[72:75], v[136:139], v[32:35]
    ds_read_b128 v[176:179], v8 offset:1856
    v_mfma_f32_16x16x32_bf16 v[36:39], v[72:75], v[140:143], v[36:39]
    s_waitcnt lgkmcnt(14)
    ds_read2_b32 v[112:113], v6 offset0:80 offset1:81
    v_mfma_f32_16x16x32_bf16 v[40:43], v[72:75], v[144:147], v[40:43]
    s_waitcnt lgkmcnt(14)
    ds_read2_b32 v[114:115], v6 offset0:82 offset1:83
    v_mfma_f32_16x16x32_bf16 v[44:47], v[72:75], v[148:151], v[44:47]
    s_waitcnt lgkmcnt(14)
    ds_read_b128 v[180:183], v8 offset:1344
    v_mfma_f32_16x16x32_bf16 v[28:31], v[76:79], v[128:131], v[28:31]
    s_waitcnt lgkmcnt(14)
    ds_read2_b32 v[116:117], v6 offset0:208 offset1:209
    v_mfma_f32_16x16x32_bf16 v[32:35], v[76:79], v[132:135], v[32:35]
    s_waitcnt lgkmcnt(14)
    ds_read2_b32 v[118:119], v6 offset0:210 offset1:211
    v_mfma_f32_16x16x32_bf16 v[36:39], v[76:79], v[136:139], v[36:39]
    s_waitcnt lgkmcnt(14)
    ds_read_b128 v[184:187], v8 offset:832
    v_mfma_f32_16x16x32_bf16 v[40:43], v[76:79], v[140:143], v[40:43]
    s_waitcnt lgkmcnt(14)
    ds_read2_b32 v[120:121], v7 offset0:80 offset1:81
    v_mfma_f32_16x16x32_bf16 v[44:47], v[76:79], v[144:147], v[44:47]
    s_waitcnt lgkmcnt(14)
    ds_read2_b32 v[122:123], v7 offset0:82 offset1:83
    v_mfma_f32_16x16x32_bf16 v[32:35], v[80:83], v[128:131], v[32:35]
    s_waitcnt lgkmcnt(14)
    ds_read_b128 v[188:191], v8 offset:320
    v_mfma_f32_16x16x32_bf16 v[36:39], v[80:83], v[132:135], v[36:39]
    s_waitcnt lgkmcnt(14)
    ds_read2_b32 v[124:125], v7 offset0:208 offset1:209
    v_mfma_f32_16x16x32_bf16 v[40:43], v[80:83], v[136:139], v[40:43]
    s_waitcnt lgkmcnt(14)
    ds_read2_b32 v[126:127], v7 offset0:210 offset1:211
    v_mfma_f32_16x16x32_bf16 v[44:47], v[80:83], v[140:143], v[44:47]
    v_mfma_f32_16x16x32_bf16 v[36:39], v[84:87], v[128:131], v[36:39]
    v_mfma_f32_16x16x32_bf16 v[40:43], v[84:87], v[132:135], v[40:43]
    v_mfma_f32_16x16x32_bf16 v[44:47], v[84:87], v[136:139], v[44:47]
    v_mfma_f32_16x16x32_bf16 v[40:43], v[88:91], v[128:131], v[40:43]
    v_mfma_f32_16x16x32_bf16 v[44:47], v[88:91], v[132:135], v[44:47]
    v_mfma_f32_16x16x32_bf16 v[44:47], v[92:95], v[128:131], v[44:47]
    v_mfma_f32_16x16x32_bf16 v[16:19], v[96:99], v[160:163], v[16:19]
    v_mfma_f32_16x16x32_bf16 v[20:23], v[96:99], v[164:167], v[20:23]
    v_mfma_f32_16x16x32_bf16 v[24:27], v[96:99], v[168:171], v[24:27]
    s_waitcnt lgkmcnt(14)
    v_mfma_f32_16x16x32_bf16 v[28:31], v[96:99], v[172:175], v[28:31]
    s_waitcnt lgkmcnt(11)
    v_mfma_f32_16x16x32_bf16 v[32:35], v[96:99], v[176:179], v[32:35]
    s_waitcnt lgkmcnt(8)
    v_mfma_f32_16x16x32_bf16 v[36:39], v[96:99], v[180:183], v[36:39]
    ds_read_b128 v[128:131], v8 offset:3968
    s_waitcnt lgkmcnt(6)
    v_mfma_f32_16x16x32_bf16 v[40:43], v[96:99], v[184:187], v[40:43]
    ds_read2_b32 v[64:65], v4 offset0:96 offset1:97
    s_waitcnt lgkmcnt(4)
    v_mfma_f32_16x16x32_bf16 v[44:47], v[96:99], v[188:191], v[44:47]
    ds_read2_b32 v[66:67], v4 offset0:98 offset1:99
    v_mfma_f32_16x16x32_bf16 v[20:23], v[100:103], v[160:163], v[20:23]
    ds_read_b128 v[132:135], v8 offset:3456
    v_mfma_f32_16x16x32_bf16 v[24:27], v[100:103], v[164:167], v[24:27]
    ds_read2_b32 v[68:69], v4 offset0:224 offset1:225
    v_mfma_f32_16x16x32_bf16 v[28:31], v[100:103], v[168:171], v[28:31]
    ds_read2_b32 v[70:71], v4 offset0:226 offset1:227
    v_mfma_f32_16x16x32_bf16 v[32:35], v[100:103], v[172:175], v[32:35]
    ds_read_b128 v[136:139], v8 offset:2944
    v_mfma_f32_16x16x32_bf16 v[36:39], v[100:103], v[176:179], v[36:39]
    ds_read2_b32 v[72:73], v5 offset0:96 offset1:97
    v_mfma_f32_16x16x32_bf16 v[40:43], v[100:103], v[180:183], v[40:43]
    ds_read2_b32 v[74:75], v5 offset0:98 offset1:99
    v_mfma_f32_16x16x32_bf16 v[44:47], v[100:103], v[184:187], v[44:47]
    ds_read_b128 v[140:143], v8 offset:2432
    v_mfma_f32_16x16x32_bf16 v[24:27], v[104:107], v[160:163], v[24:27]
    ds_read2_b32 v[76:77], v5 offset0:224 offset1:225
    v_mfma_f32_16x16x32_bf16 v[28:31], v[104:107], v[164:167], v[28:31]
    ds_read2_b32 v[78:79], v5 offset0:226 offset1:227
    v_mfma_f32_16x16x32_bf16 v[32:35], v[104:107], v[168:171], v[32:35]
    ds_read_b128 v[144:147], v8 offset:1920
    v_mfma_f32_16x16x32_bf16 v[36:39], v[104:107], v[172:175], v[36:39]
    s_waitcnt lgkmcnt(14)
    ds_read2_b32 v[80:81], v6 offset0:96 offset1:97
    v_mfma_f32_16x16x32_bf16 v[40:43], v[104:107], v[176:179], v[40:43]
    s_waitcnt lgkmcnt(14)
    ds_read2_b32 v[82:83], v6 offset0:98 offset1:99
    v_mfma_f32_16x16x32_bf16 v[44:47], v[104:107], v[180:183], v[44:47]
    s_waitcnt lgkmcnt(14)
    ds_read_b128 v[148:151], v8 offset:1408
    v_mfma_f32_16x16x32_bf16 v[28:31], v[108:111], v[160:163], v[28:31]
    s_waitcnt lgkmcnt(14)
    ds_read2_b32 v[84:85], v6 offset0:224 offset1:225
    v_mfma_f32_16x16x32_bf16 v[32:35], v[108:111], v[164:167], v[32:35]
    s_waitcnt lgkmcnt(14)
    ds_read2_b32 v[86:87], v6 offset0:226 offset1:227
    v_mfma_f32_16x16x32_bf16 v[36:39], v[108:111], v[168:171], v[36:39]
    s_waitcnt lgkmcnt(14)
    ds_read_b128 v[152:155], v8 offset:896
    v_mfma_f32_16x16x32_bf16 v[40:43], v[108:111], v[172:175], v[40:43]
    s_waitcnt lgkmcnt(14)
    ds_read2_b32 v[88:89], v7 offset0:96 offset1:97
    v_mfma_f32_16x16x32_bf16 v[44:47], v[108:111], v[176:179], v[44:47]
    s_waitcnt lgkmcnt(14)
    ds_read2_b32 v[90:91], v7 offset0:98 offset1:99
    v_mfma_f32_16x16x32_bf16 v[32:35], v[112:115], v[160:163], v[32:35]
    s_waitcnt lgkmcnt(14)
    ds_read_b128 v[156:159], v8 offset:384
    v_mfma_f32_16x16x32_bf16 v[36:39], v[112:115], v[164:167], v[36:39]
    s_waitcnt lgkmcnt(14)
    ds_read2_b32 v[92:93], v7 offset0:224 offset1:225
    v_mfma_f32_16x16x32_bf16 v[40:43], v[112:115], v[168:171], v[40:43]
    s_waitcnt lgkmcnt(14)
    ds_read2_b32 v[94:95], v7 offset0:226 offset1:227
    v_mfma_f32_16x16x32_bf16 v[44:47], v[112:115], v[172:175], v[44:47]
    v_mfma_f32_16x16x32_bf16 v[36:39], v[116:119], v[160:163], v[36:39]
    v_mfma_f32_16x16x32_bf16 v[40:43], v[116:119], v[164:167], v[40:43]
    v_mfma_f32_16x16x32_bf16 v[44:47], v[116:119], v[168:171], v[44:47]
    v_mfma_f32_16x16x32_bf16 v[40:43], v[120:123], v[160:163], v[40:43]
    v_mfma_f32_16x16x32_bf16 v[44:47], v[120:123], v[164:167], v[44:47]
    v_mfma_f32_16x16x32_bf16 v[44:47], v[124:127], v[160:163], v[44:47]
    s_setprio 0
    v_mfma_f32_16x16x32_bf16 v[16:19], v[64:67], v[128:131], v[16:19]
    v_mfma_f32_16x16x32_bf16 v[20:23], v[64:67], v[132:135], v[20:23]
    v_mfma_f32_16x16x32_bf16 v[24:27], v[64:67], v[136:139], v[24:27]
    s_waitcnt lgkmcnt(14)
    v_mfma_f32_16x16x32_bf16 v[28:31], v[64:67], v[140:143], v[28:31]
    s_waitcnt lgkmcnt(11)
    v_mfma_f32_16x16x32_bf16 v[32:35], v[64:67], v[144:147], v[32:35]
    s_waitcnt lgkmcnt(8)
    v_mfma_f32_16x16x32_bf16 v[36:39], v[64:67], v[148:151], v[36:39]
    ds_read_b128 v[160:163], v8 offset:4032
    s_waitcnt lgkmcnt(6)
    v_mfma_f32_16x16x32_bf16 v[40:43], v[64:67], v[152:155], v[40:43]
    ds_read2_b32 v[96:97], v4 offset0:112 offset1:113
    s_waitcnt lgkmcnt(4)
    v_mfma_f32_16x16x32_bf16 v[44:47], v[64:67], v[156:159], v[44:47]
    ds_read2_b32 v[98:99], v4 offset0:114 offset1:115
    v_mfma_f32_16x16x32_bf16 v[20:23], v[68:71], v[128:131], v[20:23]
    ds_read_b128 v[164:167], v8 offset:3520
    v_mfma_f32_16x16x32_bf16 v[24:27], v[68:71], v[132:135], v[24:27]
    ds_read2_b32 v[100:101], v4 offset0:240 offset1:241
    v_mfma_f32_16x16x32_bf16 v[28:31], v[68:71], v[136:139], v[28:31]
    ds_read2_b32 v[102:103], v4 offset0:242 offset1:243
    v_mfma_f32_16x16x32_bf16 v[32:35], v[68:71], v[140:143], v[32:35]
    ds_read_b128 v[168:171], v8 offset:3008
    v_mfma_f32_16x16x32_bf16 v[36:39], v[68:71], v[144:147], v[36:39]
    ds_read2_b32 v[104:105], v5 offset0:112 offset1:113
    v_mfma_f32_16x16x32_bf16 v[40:43], v[68:71], v[148:151], v[40:43]
    ds_read2_b32 v[106:107], v5 offset0:114 offset1:115
    v_mfma_f32_16x16x32_bf16 v[44:47], v[68:71], v[152:155], v[44:47]
    ds_read_b128 v[172:175], v8 offset:2496
    v_mfma_f32_16x16x32_bf16 v[24:27], v[72:75], v[128:131], v[24:27]
    ds_read2_b32 v[108:109], v5 offset0:240 offset1:241
    v_mfma_f32_16x16x32_bf16 v[28:31], v[72:75], v[132:135], v[28:31]
    ds_read2_b32 v[110:111], v5 offset0:242 offset1:243
    v_mfma_f32_16x16x32_bf16 v[32:35], v[72:75], v[136:139], v[32:35]
    ds_read_b128 v[176:179], v8 offset:1984
    v_mfma_f32_16x16x32_bf16 v[36:39], v[72:75], v[140:143], v[36:39]
    s_waitcnt lgkmcnt(14)
    ds_read2_b32 v[112:113], v6 offset0:112 offset1:113
    v_mfma_f32_16x16x32_bf16 v[40:43], v[72:75], v[144:147], v[40:43]
    s_waitcnt lgkmcnt(14)
    ds_read2_b32 v[114:115], v6 offset0:114 offset1:115
    v_mfma_f32_16x16x32_bf16 v[44:47], v[72:75], v[148:151], v[44:47]
    s_waitcnt lgkmcnt(14)
    ds_read_b128 v[180:183], v8 offset:1472
    v_mfma_f32_16x16x32_bf16 v[28:31], v[76:79], v[128:131], v[28:31]
    s_waitcnt lgkmcnt(14)
    ds_read2_b32 v[116:117], v6 offset0:240 offset1:241
    v_mfma_f32_16x16x32_bf16 v[32:35], v[76:79], v[132:135], v[32:35]
    s_waitcnt lgkmcnt(14)
    ds_read2_b32 v[118:119], v6 offset0:242 offset1:243
    v_mfma_f32_16x16x32_bf16 v[36:39], v[76:79], v[136:139], v[36:39]
    s_waitcnt lgkmcnt(14)
    ds_read_b128 v[184:187], v8 offset:960
    v_mfma_f32_16x16x32_bf16 v[40:43], v[76:79], v[140:143], v[40:43]
    s_waitcnt lgkmcnt(14)
    ds_read2_b32 v[120:121], v7 offset0:112 offset1:113
    v_mfma_f32_16x16x32_bf16 v[44:47], v[76:79], v[144:147], v[44:47]
    s_waitcnt lgkmcnt(14)
    ds_read2_b32 v[122:123], v7 offset0:114 offset1:115
    v_mfma_f32_16x16x32_bf16 v[32:35], v[80:83], v[128:131], v[32:35]
    s_waitcnt lgkmcnt(14)
    ds_read_b128 v[188:191], v8 offset:448
    v_mfma_f32_16x16x32_bf16 v[36:39], v[80:83], v[132:135], v[36:39]
    s_waitcnt lgkmcnt(14)
    ds_read2_b32 v[124:125], v7 offset0:240 offset1:241
    v_mfma_f32_16x16x32_bf16 v[40:43], v[80:83], v[136:139], v[40:43]
    s_waitcnt lgkmcnt(14)
    ds_read2_b32 v[126:127], v7 offset0:242 offset1:243
    v_mfma_f32_16x16x32_bf16 v[44:47], v[80:83], v[140:143], v[44:47]
    v_mfma_f32_16x16x32_bf16 v[36:39], v[84:87], v[128:131], v[36:39]
    v_mfma_f32_16x16x32_bf16 v[40:43], v[84:87], v[132:135], v[40:43]
    v_mfma_f32_16x16x32_bf16 v[44:47], v[84:87], v[136:139], v[44:47]
    v_mfma_f32_16x16x32_bf16 v[40:43], v[88:91], v[128:131], v[40:43]
    v_mfma_f32_16x16x32_bf16 v[44:47], v[88:91], v[132:135], v[44:47]
    v_mfma_f32_16x16x32_bf16 v[44:47], v[92:95], v[128:131], v[44:47]
    v_mfma_f32_16x16x32_bf16 v[16:19], v[96:99], v[160:163], v[16:19]
    v_mfma_f32_16x16x32_bf16 v[20:23], v[96:99], v[164:167], v[20:23]
    v_mfma_f32_16x16x32_bf16 v[24:27], v[96:99], v[168:171], v[24:27]
    s_waitcnt lgkmcnt(14)
    v_mfma_f32_16x16x32_bf16 v[28:31], v[96:99], v[172:175], v[28:31]
    s_waitcnt lgkmcnt(11)
    v_mfma_f32_16x16x32_bf16 v[32:35], v[96:99], v[176:179], v[32:35]
    s_waitcnt lgkmcnt(8)
    v_mfma_f32_16x16x32_bf16 v[36:39], v[96:99], v[180:183], v[36:39]
    ds_read_b128 v[128:131], v52 offset:3584
    s_waitcnt lgkmcnt(6)
    v_mfma_f32_16x16x32_bf16 v[40:43], v[96:99], v[184:187], v[40:43]
    ds_read2_b32 v[64:65], v48 offset0:0 offset1:1
    s_waitcnt lgkmcnt(4)
    v_mfma_f32_16x16x32_bf16 v[44:47], v[96:99], v[188:191], v[44:47]
    ds_read2_b32 v[66:67], v48 offset0:2 offset1:3
    v_mfma_f32_16x16x32_bf16 v[20:23], v[100:103], v[160:163], v[20:23]
    ds_read_b128 v[132:135], v52 offset:3072
    v_mfma_f32_16x16x32_bf16 v[24:27], v[100:103], v[164:167], v[24:27]
    ds_read2_b32 v[68:69], v48 offset0:128 offset1:129
    v_mfma_f32_16x16x32_bf16 v[28:31], v[100:103], v[168:171], v[28:31]
    ds_read2_b32 v[70:71], v48 offset0:130 offset1:131
    v_mfma_f32_16x16x32_bf16 v[32:35], v[100:103], v[172:175], v[32:35]
    ds_read_b128 v[136:139], v52 offset:2560
    v_mfma_f32_16x16x32_bf16 v[36:39], v[100:103], v[176:179], v[36:39]
    ds_read2_b32 v[72:73], v49 offset0:0 offset1:1
    v_mfma_f32_16x16x32_bf16 v[40:43], v[100:103], v[180:183], v[40:43]
    ds_read2_b32 v[74:75], v49 offset0:2 offset1:3
    v_mfma_f32_16x16x32_bf16 v[44:47], v[100:103], v[184:187], v[44:47]
    ds_read_b128 v[140:143], v52 offset:2048
    v_mfma_f32_16x16x32_bf16 v[24:27], v[104:107], v[160:163], v[24:27]
    ds_read2_b32 v[76:77], v49 offset0:128 offset1:129
    v_mfma_f32_16x16x32_bf16 v[28:31], v[104:107], v[164:167], v[28:31]
    ds_read2_b32 v[78:79], v49 offset0:130 offset1:131
    v_mfma_f32_16x16x32_bf16 v[32:35], v[104:107], v[168:171], v[32:35]
    ds_read_b128 v[144:147], v52 offset:1536
    v_mfma_f32_16x16x32_bf16 v[36:39], v[104:107], v[172:175], v[36:39]
    s_waitcnt lgkmcnt(14)
    ds_read2_b32 v[80:81], v50 offset0:0 offset1:1
    v_mfma_f32_16x16x32_bf16 v[40:43], v[104:107], v[176:179], v[40:43]
    s_waitcnt lgkmcnt(14)
    ds_read2_b32 v[82:83], v50 offset0:2 offset1:3
    v_mfma_f32_16x16x32_bf16 v[44:47], v[104:107], v[180:183], v[44:47]
    s_waitcnt lgkmcnt(14)
    ds_read_b128 v[148:151], v52 offset:1024
    v_mfma_f32_16x16x32_bf16 v[28:31], v[108:111], v[160:163], v[28:31]
    s_waitcnt lgkmcnt(14)
    ds_read2_b32 v[84:85], v50 offset0:128 offset1:129
    v_mfma_f32_16x16x32_bf16 v[32:35], v[108:111], v[164:167], v[32:35]
    s_waitcnt lgkmcnt(14)
    ds_read2_b32 v[86:87], v50 offset0:130 offset1:131
    v_mfma_f32_16x16x32_bf16 v[36:39], v[108:111], v[168:171], v[36:39]
    s_waitcnt lgkmcnt(14)
    ds_read_b128 v[152:155], v52 offset:512
    v_mfma_f32_16x16x32_bf16 v[40:43], v[108:111], v[172:175], v[40:43]
    s_waitcnt lgkmcnt(14)
    ds_read2_b32 v[88:89], v51 offset0:0 offset1:1
    v_mfma_f32_16x16x32_bf16 v[44:47], v[108:111], v[176:179], v[44:47]
    s_waitcnt lgkmcnt(14)
    ds_read2_b32 v[90:91], v51 offset0:2 offset1:3
    v_mfma_f32_16x16x32_bf16 v[32:35], v[112:115], v[160:163], v[32:35]
    s_waitcnt lgkmcnt(14)
    ds_read_b128 v[156:159], v52 offset:0
    v_mfma_f32_16x16x32_bf16 v[36:39], v[112:115], v[164:167], v[36:39]
    s_waitcnt lgkmcnt(14)
    ds_read2_b32 v[92:93], v51 offset0:128 offset1:129
    v_mfma_f32_16x16x32_bf16 v[40:43], v[112:115], v[168:171], v[40:43]
    s_waitcnt lgkmcnt(14)
    ds_read2_b32 v[94:95], v51 offset0:130 offset1:131
    v_mfma_f32_16x16x32_bf16 v[44:47], v[112:115], v[172:175], v[44:47]
    v_mfma_f32_16x16x32_bf16 v[36:39], v[116:119], v[160:163], v[36:39]
    v_mfma_f32_16x16x32_bf16 v[40:43], v[116:119], v[164:167], v[40:43]
    v_mfma_f32_16x16x32_bf16 v[44:47], v[116:119], v[168:171], v[44:47]
    v_mfma_f32_16x16x32_bf16 v[40:43], v[120:123], v[160:163], v[40:43]
    v_mfma_f32_16x16x32_bf16 v[44:47], v[120:123], v[164:167], v[44:47]
    v_mfma_f32_16x16x32_bf16 v[44:47], v[124:127], v[160:163], v[44:47]
    v_mfma_f32_16x16x32_bf16 v[196:199], v[64:67], v[128:131], 0
    v_mfma_f32_16x16x32_bf16 v[200:203], v[64:67], v[132:135], 0
    v_mfma_f32_16x16x32_bf16 v[204:207], v[64:67], v[136:139], 0
    s_waitcnt lgkmcnt(14)
    v_mfma_f32_16x16x32_bf16 v[208:211], v[64:67], v[140:143], 0
    s_waitcnt lgkmcnt(11)
    v_mfma_f32_16x16x32_bf16 v[212:215], v[64:67], v[144:147], 0
    s_waitcnt lgkmcnt(8)
    v_mfma_f32_16x16x32_bf16 v[216:219], v[64:67], v[148:151], 0
    s_waitcnt lgkmcnt(5)
    v_mfma_f32_16x16x32_bf16 v[220:223], v[64:67], v[152:155], 0
    s_waitcnt lgkmcnt(2)
    v_mfma_f32_16x16x32_bf16 v[224:227], v[64:67], v[156:159], 0
    v_mfma_f32_16x16x32_bf16 v[200:203], v[68:71], v[128:131], v[200:203]
    v_mfma_f32_16x16x32_bf16 v[204:207], v[68:71], v[132:135], v[204:207]
    v_mfma_f32_16x16x32_bf16 v[208:211], v[68:71], v[136:139], v[208:211]
    v_mfma_f32_16x16x32_bf16 v[212:215], v[68:71], v[140:143], v[212:215]
    v_mfma_f32_16x16x32_bf16 v[216:219], v[68:71], v[144:147], v[216:219]
    v_mfma_f32_16x16x32_bf16 v[220:223], v[68:71], v[148:151], v[220:223]
    v_mfma_f32_16x16x32_bf16 v[224:227], v[68:71], v[152:155], v[224:227]
    v_mfma_f32_16x16x32_bf16 v[204:207], v[72:75], v[128:131], v[204:207]
    v_mfma_f32_16x16x32_bf16 v[208:211], v[72:75], v[132:135], v[208:211]
    v_mfma_f32_16x16x32_bf16 v[212:215], v[72:75], v[136:139], v[212:215]
    v_mfma_f32_16x16x32_bf16 v[216:219], v[72:75], v[140:143], v[216:219]
    v_mfma_f32_16x16x32_bf16 v[220:223], v[72:75], v[144:147], v[220:223]
    v_mfma_f32_16x16x32_bf16 v[224:227], v[72:75], v[148:151], v[224:227]
    v_mfma_f32_16x16x32_bf16 v[208:211], v[76:79], v[128:131], v[208:211]
    v_mfma_f32_16x16x32_bf16 v[212:215], v[76:79], v[132:135], v[212:215]
    v_mfma_f32_16x16x32_bf16 v[216:219], v[76:79], v[136:139], v[216:219]
    v_mfma_f32_16x16x32_bf16 v[220:223], v[76:79], v[140:143], v[220:223]
    v_mfma_f32_16x16x32_bf16 v[224:227], v[76:79], v[144:147], v[224:227]
    v_mfma_f32_16x16x32_bf16 v[212:215], v[80:83], v[128:131], v[212:215]
    v_mfma_f32_16x16x32_bf16 v[216:219], v[80:83], v[132:135], v[216:219]
    v_mfma_f32_16x16x32_bf16 v[220:223], v[80:83], v[136:139], v[220:223]
    v_mfma_f32_16x16x32_bf16 v[224:227], v[80:83], v[140:143], v[224:227]
    v_mfma_f32_16x16x32_bf16 v[216:219], v[84:87], v[128:131], v[216:219]
    v_mfma_f32_16x16x32_bf16 v[220:223], v[84:87], v[132:135], v[220:223]
    v_mfma_f32_16x16x32_bf16 v[224:227], v[84:87], v[136:139], v[224:227]
    v_mfma_f32_16x16x32_bf16 v[220:223], v[88:91], v[128:131], v[220:223]
    v_mfma_f32_16x16x32_bf16 v[224:227], v[88:91], v[132:135], v[224:227]
    s_waitcnt lgkmcnt(0)
    v_mfma_f32_16x16x32_bf16 v[224:227], v[92:95], v[128:131], v[224:227]
    ds_read_b64 v[96:97], v9 offset:3584
    ds_read_b64 v[98:99], v9 offset:3072
    ds_read_b64 v[100:101], v9 offset:2560
    ds_read_b64 v[102:103], v9 offset:2048
    ds_read_b64 v[104:105], v9 offset:1536
    ds_read_b64 v[106:107], v9 offset:1024
    ds_read_b64 v[108:109], v9 offset:512
    ds_read_b64 v[110:111], v9 offset:0
    s_lshl_b32 s35, s31, 12
    s_add_u32 s35, s35, 30670848
    s_waitcnt lgkmcnt(7)
    v_and_b32 v120, 0xffff0000, v97
    v_lshlrev_b32 v121, 16, v97
    v_and_b32 v122, 0xffff0000, v96
    v_lshlrev_b32 v123, 16, v96
    v_fma_f32 v120, v120, s33, v16
    v_fma_f32 v121, v121, s33, v17
    v_fma_f32 v122, v122, s33, v18
    v_fma_f32 v123, v123, s33, v19
    v_cvt_pk_bf16_f32 v124, v120, v121
    v_cvt_pk_bf16_f32 v125, v122, v123
    buffer_store_dwordx2 v[124:125], v10, s[20:23], s35 offen offset:0 sc1
    s_waitcnt lgkmcnt(6)
    v_and_b32 v120, 0xffff0000, v99
    v_lshlrev_b32 v121, 16, v99
    v_and_b32 v122, 0xffff0000, v98
    v_lshlrev_b32 v123, 16, v98
    v_fma_f32 v120, v120, s33, v20
    v_fma_f32 v121, v121, s33, v21
    v_fma_f32 v122, v122, s33, v22
    v_fma_f32 v123, v123, s33, v23
    v_cvt_pk_bf16_f32 v126, v120, v121
    v_cvt_pk_bf16_f32 v127, v122, v123
    buffer_store_dwordx2 v[126:127], v10, s[20:23], s35 offen offset:512 sc1
    s_waitcnt lgkmcnt(5)
    v_and_b32 v120, 0xffff0000, v101
    v_lshlrev_b32 v121, 16, v101
    v_and_b32 v122, 0xffff0000, v100
    v_lshlrev_b32 v123, 16, v100
    v_fma_f32 v120, v120, s33, v24
    v_fma_f32 v121, v121, s33, v25
    v_fma_f32 v122, v122, s33, v26
    v_fma_f32 v123, v123, s33, v27
    v_cvt_pk_bf16_f32 v124, v120, v121
    v_cvt_pk_bf16_f32 v125, v122, v123
    buffer_store_dwordx2 v[124:125], v10, s[20:23], s35 offen offset:1024 sc1
    s_waitcnt lgkmcnt(4)
    v_and_b32 v120, 0xffff0000, v103
    v_lshlrev_b32 v121, 16, v103
    v_and_b32 v122, 0xffff0000, v102
    v_lshlrev_b32 v123, 16, v102
    v_fma_f32 v120, v120, s33, v28
    v_fma_f32 v121, v121, s33, v29
    v_fma_f32 v122, v122, s33, v30
    v_fma_f32 v123, v123, s33, v31
    v_cvt_pk_bf16_f32 v126, v120, v121
    v_cvt_pk_bf16_f32 v127, v122, v123
    buffer_store_dwordx2 v[126:127], v10, s[20:23], s35 offen offset:1536 sc1
    s_waitcnt lgkmcnt(3)
    v_and_b32 v120, 0xffff0000, v105
    v_lshlrev_b32 v121, 16, v105
    v_and_b32 v122, 0xffff0000, v104
    v_lshlrev_b32 v123, 16, v104
    v_fma_f32 v120, v120, s33, v32
    v_fma_f32 v121, v121, s33, v33
    v_fma_f32 v122, v122, s33, v34
    v_fma_f32 v123, v123, s33, v35
    v_cvt_pk_bf16_f32 v124, v120, v121
    v_cvt_pk_bf16_f32 v125, v122, v123
    buffer_store_dwordx2 v[124:125], v10, s[20:23], s35 offen offset:2048 sc1
    s_waitcnt lgkmcnt(2)
    v_and_b32 v120, 0xffff0000, v107
    v_lshlrev_b32 v121, 16, v107
    v_and_b32 v122, 0xffff0000, v106
    v_lshlrev_b32 v123, 16, v106
    v_fma_f32 v120, v120, s33, v36
    v_fma_f32 v121, v121, s33, v37
    v_fma_f32 v122, v122, s33, v38
    v_fma_f32 v123, v123, s33, v39
    v_cvt_pk_bf16_f32 v126, v120, v121
    v_cvt_pk_bf16_f32 v127, v122, v123
    buffer_store_dwordx2 v[126:127], v10, s[20:23], s35 offen offset:2560 sc1
    s_waitcnt lgkmcnt(1)
    v_and_b32 v120, 0xffff0000, v109
    v_lshlrev_b32 v121, 16, v109
    v_and_b32 v122, 0xffff0000, v108
    v_lshlrev_b32 v123, 16, v108
    v_fma_f32 v120, v120, s33, v40
    v_fma_f32 v121, v121, s33, v41
    v_fma_f32 v122, v122, s33, v42
    v_fma_f32 v123, v123, s33, v43
    v_cvt_pk_bf16_f32 v124, v120, v121
    v_cvt_pk_bf16_f32 v125, v122, v123
    buffer_store_dwordx2 v[124:125], v10, s[20:23], s35 offen offset:3072 sc1
    s_waitcnt lgkmcnt(0)
    v_and_b32 v120, 0xffff0000, v111
    v_lshlrev_b32 v121, 16, v111
    v_and_b32 v122, 0xffff0000, v110
    v_lshlrev_b32 v123, 16, v110
    v_fma_f32 v120, v120, s33, v44
    v_fma_f32 v121, v121, s33, v45
    v_fma_f32 v122, v122, s33, v46
    v_fma_f32 v123, v123, s33, v47
    v_cvt_pk_bf16_f32 v126, v120, v121
    v_cvt_pk_bf16_f32 v127, v122, v123
    buffer_store_dwordx2 v[126:127], v10, s[20:23], s35 offen offset:3584 sc1
    s_nop 7
    ds_write_b128 v13, v[196:199] offset:0
    ds_write_b128 v13, v[200:203] offset:1024
    ds_write_b128 v13, v[204:207] offset:2048
    ds_write_b128 v13, v[208:211] offset:3072
    ds_write_b128 v13, v[212:215] offset:4096
    ds_write_b128 v13, v[216:219] offset:5120
    ds_write_b128 v13, v[220:223] offset:6144
    ds_write_b128 v13, v[224:227] offset:7168
    s_waitcnt lgkmcnt(0)
    s_barrier
    s_lshl_b32 s36, s28, 10
    v_add_u32 v54, s36, v15
    v_add_u32 v55, 51712, v54
    ds_read_b128 v[64:67], v54 offset:0
    ds_read_b128 v[68:71], v54 offset:12928
    ds_read_b128 v[72:75], v54 offset:25856
    ds_read_b128 v[76:79], v54 offset:38784
    ds_read_b128 v[80:83], v55 offset:0
    ds_read_b128 v[84:87], v55 offset:12928
    ds_read_b128 v[88:91], v55 offset:25856
    ds_read_b128 v[92:95], v55 offset:38784
    s_lshl_b32 s36, s28, 9
    s_sub_u32 s36, 115832, s36
    v_sub_u32 v54, s36, v10
    ds_read_b64 v[20:21], v54
    s_mul_i32 s35, s29, 9
    s_add_u32 s35, s35, 8
    s_lshl_b32 s35, s35, 12
    s_lshl_b32 s36, s28, 9
    s_add_u32 s35, s35, s36
    s_add_u32 s35, s35, 30670848
    s_waitcnt lgkmcnt(0)
    v_add_f32 v64, v64, v68
    v_add_f32 v65, v65, v69
    v_add_f32 v66, v66, v70
    v_add_f32 v67, v67, v71
    v_add_f32 v64, v64, v72
    v_add_f32 v65, v65, v73
    v_add_f32 v66, v66, v74
    v_add_f32 v67, v67, v75
    v_add_f32 v64, v64, v76
    v_add_f32 v65, v65, v77
    v_add_f32 v66, v66, v78
    v_add_f32 v67, v67, v79
    v_add_f32 v64, v64, v80
    v_add_f32 v65, v65, v81
    v_add_f32 v66, v66, v82
    v_add_f32 v67, v67, v83
    v_add_f32 v64, v64, v84
    v_add_f32 v65, v65, v85
    v_add_f32 v66, v66, v86
    v_add_f32 v67, v67, v87
    v_add_f32 v64, v64, v88
    v_add_f32 v65, v65, v89
    v_add_f32 v66, v66, v90
    v_add_f32 v67, v67, v91
    v_add_f32 v64, v64, v92
    v_add_f32 v65, v65, v93
    v_add_f32 v66, v66, v94
    v_add_f32 v67, v67, v95
    v_and_b32 v120, 0xffff0000, v21
    v_lshlrev_b32 v121, 16, v21
    v_and_b32 v122, 0xffff0000, v20
    v_lshlrev_b32 v123, 16, v20
    v_fma_f32 v120, v120, s34, v64
    v_fma_f32 v121, v121, s34, v65
    v_fma_f32 v122, v122, s34, v66
    v_fma_f32 v123, v123, s34, v67
    v_cvt_pk_bf16_f32 v124, v120, v121
    v_cvt_pk_bf16_f32 v125, v122, v123
    buffer_store_dwordx2 v[124:125], v10, s[20:23], s35 offen sc1
    s_waitcnt vmcnt(0)
    s_barrier
    s_cmp_eq_u32 s28, 0
    s_cbranch_scc0 Lssm_nocf
    v_lshlrev_b32 v12, 2, v1
    s_lshl_b32 s36, s29, 8
    s_add_u32 s36, s36, 33554432
    buffer_store_dword v232, v12, s[20:23], s36 offen sc1
Lssm_nocf:
    v_and_b32 v10, 31, v1
    v_lshrrev_b32 v11, 5, v1
    v_lshlrev_b32 v11, 2, v11
    v_sub_u32 v10, v10, v11
    v_mov_b32 v13, 0x3f80
    v_mov_b32 v15, 0x3f800000
    v_cmp_eq_u32 vcc, 0, v10
    s_nop 1
    v_cndmask_b32 v240, 0, v13, vcc
    v_cmp_eq_u32 vcc, 1, v10
    s_nop 1
    v_cndmask_b32 v240, v240, v15, vcc
    v_cmp_eq_u32 vcc, 2, v10
    s_nop 1
    v_cndmask_b32 v241, 0, v13, vcc
    v_cmp_eq_u32 vcc, 3, v10
    s_nop 1
    v_cndmask_b32 v241, v241, v15, vcc
    v_cmp_eq_u32 vcc, 8, v10
    s_nop 1
    v_cndmask_b32 v242, 0, v13, vcc
    v_cmp_eq_u32 vcc, 9, v10
    s_nop 1
    v_cndmask_b32 v242, v242, v15, vcc
    v_cmp_eq_u32 vcc, 10, v10
    s_nop 1
    v_cndmask_b32 v243, 0, v13, vcc
    v_cmp_eq_u32 vcc, 11, v10
    s_nop 1
    v_cndmask_b32 v243, v243, v15, vcc
    v_cmp_eq_u32 vcc, 16, v10
    s_nop 1
    v_cndmask_b32 v244, 0, v13, vcc
    v_cmp_eq_u32 vcc, 17, v10
    s_nop 1
    v_cndmask_b32 v244, v244, v15, vcc
    v_cmp_eq_u32 vcc, 18, v10
    s_nop 1
    v_cndmask_b32 v245, 0, v13, vcc
    v_cmp_eq_u32 vcc, 19, v10
    s_nop 1
    v_cndmask_b32 v245, v245, v15, vcc
    v_cmp_eq_u32 vcc, 24, v10
    s_nop 1
    v_cndmask_b32 v246, 0, v13, vcc
    v_cmp_eq_u32 vcc, 25, v10
    s_nop 1
    v_cndmask_b32 v246, v246, v15, vcc
    v_cmp_eq_u32 vcc, 26, v10
    s_nop 1
    v_cndmask_b32 v247, 0, v13, vcc
    v_cmp_eq_u32 vcc, 27, v10
    s_nop 1
    v_cndmask_b32 v247, v247, v15, vcc
    s_lshr_b32 s30, s29, 2
    s_and_b32 s31, s29, 3
    s_add_u32 s34, s28, 0
    s_and_b32 s5, s34, 1
    s_lshr_b32 s34, s34, 1
    s_and_b32 s35, s30, 7
    s_add_u32 s34, s34, s35
    s_sub_u32 s35, s34, 9
    s_min_u32 s34, s34, s35
    s_lshl_b32 s34, s34, 1
    s_add_u32 s12, s34, s5
    s_lshl_b32 s34, s30, 2
    s_add_u32 s34, s34, s31
    v_lshrrev_b32 v5, 5, v1
    v_and_b32 v4, 31, v1
    v_lshlrev_b32 v7, 2, v4
    s_lshl_b32 s35, s34, 7
    s_add_u32 s35, s35, 33030144
    buffer_load_dword v152, v7, s[20:23], s35 offen sc1
    v_mul_u32_u24 v6, 1152, v4
    v_lshl_add_u32 v6, v5, 4, v6
    v_lshlrev_b32 v7, 3, v5
    v_lshlrev_b32 v2, 4, v1
    s_lshl_b32 s37, s12, 6
    buffer_load_dwordx2 v[128:129], v7, s[56:59], s37 offen offset:0
    buffer_load_dwordx2 v[130:131], v7, s[56:59], s37 offen offset:16
    buffer_load_dwordx2 v[132:133], v7, s[56:59], s37 offen offset:32
    buffer_load_dwordx2 v[134:135], v7, s[56:59], s37 offen offset:48
    s_mul_i32 s36, s34, 36864
    s_add_u32 s24, s36, s37
    buffer_load_dwordx4 v[96:99], v6, s[8:11], s24 offen offset:0
    buffer_load_dwordx4 v[100:103], v6, s[8:11], s24 offen offset:32
    s_mul_i32 s35, s34, 18
    s_add_u32 s35, s35, s12
    s_mul_i32 s35, s35, 24576
    s_add_u32 s16, s35, 0
Lpre_a1:
    s_waitcnt vmcnt(0)
    v_permlane32_swap_b32 v96, v98
    v_permlane32_swap_b32 v97, v99
    v_permlane32_swap_b32 v100, v102
    v_permlane32_swap_b32 v101, v103
    v_sub_f32 v24, 1.0, v152
    v_lshlrev_b32 v184, 16, v96
    v_and_b32 v185, 0xffff0000, v96
    v_lshlrev_b32 v186, 16, v97
    v_and_b32 v187, 0xffff0000, v97
    v_lshlrev_b32 v188, 16, v98
    v_and_b32 v189, 0xffff0000, v98
    v_lshlrev_b32 v190, 16, v99
    v_and_b32 v191, 0xffff0000, v99
    v_lshlrev_b32 v192, 16, v100
    v_and_b32 v193, 0xffff0000, v100
    v_lshlrev_b32 v194, 16, v101
    v_and_b32 v195, 0xffff0000, v101
    v_lshlrev_b32 v196, 16, v102
    v_and_b32 v197, 0xffff0000, v102
    v_lshlrev_b32 v198, 16, v103
    v_and_b32 v199, 0xffff0000, v103
    v_mul_f32 v184, v184, v152
    v_mul_f32 v185, v185, v152
    v_mul_f32 v186, v186, v152
    v_mul_f32 v187, v187, v152
    v_mul_f32 v188, v188, v152
    v_mul_f32 v189, v189, v152
    v_mul_f32 v190, v190, v152
    v_mul_f32 v191, v191, v152
    v_mul_f32 v192, v192, v152
    v_mul_f32 v193, v193, v152
    v_mul_f32 v194, v194, v152
    v_mul_f32 v195, v195, v152
    v_mul_f32 v196, v196, v152
    v_mul_f32 v197, v197, v152
    v_mul_f32 v198, v198, v152
    v_mul_f32 v199, v199, v152
Lpre_a2:
    s_cmp_eq_u32 s28, 0
    s_cbranch_scc0 Lssm_cready
    v_lshlrev_b32 v12, 8, v1
    s_mov_b32 s36, 33554432
Lssm_cpoll:
    buffer_load_dword v14, v12, s[20:23], s36 offen sc1
    s_waitcnt vmcnt(0)
    v_cmp_eq_u32 vcc, s64, v14
    s_nop 1
    s_cmp_eq_u64 vcc, -1
    s_cbranch_scc1 Lssm_cready
    s_sleep 8
    s_add_u32 s7, s7, 1
    s_cmp_lt_u32 s7, 0x40000
    s_cbranch_scc1 Lssm_cpoll
Lssm_cready:
    s_barrier
    v_lshrrev_b32 v3, 2, v1
    v_lshlrev_b32 v3, 12, v3
    v_and_b32 v4, 3, v1
    v_lshl_add_u32 v3, v4, 4, v3
    s_lshl_b32 s34, s30, 2
    s_add_u32 s34, s34, s31
    s_lshl_b32 s36, s12, 17
    s_lshl_b32 s37, s34, 6
    s_add_u32 s36, s36, s37
    s_add_u32 s36, s36, 30670848
    buffer_load_dwordx4 v[32:35], v3, s[20:23], s36 offen sc1
    s_add_u32 s36, s36, 65536
    buffer_load_dwordx4 v[36:39], v3, s[20:23], s36 offen sc1
Lpre_c1:
    s_waitcnt vmcnt(0)
    v_lshrrev_b32 v5, 5, v1
    v_and_b32 v8, 15, v1
    v_lshrrev_b32 v9, 2, v8
    v_lshl_add_u32 v9, v5, 2, v9
    v_lshlrev_b32 v9, 6, v9
    v_and_b32 v8, 3, v8
    v_lshl_add_u32 v9, v8, 3, v9
    v_lshrrev_b32 v8, 4, v1
    v_and_b32 v8, 1, v8
    v_lshl_add_u32 v9, v8, 5, v9
    v_add_u32 v9, s32, v9
    v_add_u32 v8, s32, v2
    ds_write_b128 v8, v[32:35] offset:0
    ds_write_b128 v8, v[36:39] offset:1024
Lpre_c2:
    s_waitcnt lgkmcnt(0)
    ds_read_b64_tr_b16 v[72:73], v9 offset:0
    ds_read_b64_tr_b16 v[74:75], v9 offset:512
    ds_read_b64_tr_b16 v[76:77], v9 offset:1024
    ds_read_b64_tr_b16 v[78:79], v9 offset:1536
    s_waitcnt lgkmcnt(0)
    v_lshlrev_b32 v80, 16, v72
    v_and_b32 v81, 0xffff0000, v72
    v_lshlrev_b32 v82, 16, v73
    v_and_b32 v83, 0xffff0000, v73
    v_lshlrev_b32 v84, 16, v74
    v_and_b32 v85, 0xffff0000, v74
    v_lshlrev_b32 v86, 16, v75
    v_and_b32 v87, 0xffff0000, v75
    v_lshlrev_b32 v88, 16, v76
    v_and_b32 v89, 0xffff0000, v76
    v_lshlrev_b32 v90, 16, v77
    v_and_b32 v91, 0xffff0000, v77
    v_lshlrev_b32 v92, 16, v78
    v_and_b32 v93, 0xffff0000, v78
    v_lshlrev_b32 v94, 16, v79
    v_and_b32 v95, 0xffff0000, v79
    v_mul_f32 v184, v184, v80
    v_mul_f32 v185, v185, v81
    v_mul_f32 v186, v186, v82
    v_mul_f32 v187, v187, v83
    v_mul_f32 v188, v188, v84
    v_mul_f32 v189, v189, v85
    v_mul_f32 v190, v190, v86
    v_mul_f32 v191, v191, v87
    v_mul_f32 v192, v192, v88
    v_mul_f32 v193, v193, v89
    v_mul_f32 v194, v194, v90
    v_mul_f32 v195, v195, v91
    v_mul_f32 v196, v196, v92
    v_mul_f32 v197, v197, v93
    v_mul_f32 v198, v198, v94
    v_mul_f32 v199, v199, v95
Lpre_c3:
    s_mul_i32 s6, s30, 9
    s_lshr_b32 s5, s12, 1
    s_add_u32 s6, s6, s5
    s_mul_i32 s6, s6, 3072
    s_add_u32 s6, s6, 33038336
    v_min_u32 v12, 11, v1
    v_lshlrev_b32 v12, 8, v12
Lssm_fpoll0:
    buffer_load_dword v14, v12, s[20:23], s6 offen sc1
    s_waitcnt vmcnt(0)
    v_cmp_eq_u32 vcc, s64, v14
    s_nop 1
    s_cmp_eq_u64 vcc, -1
    s_cbranch_scc1 Lssm_fready0
    s_sleep 2
    s_add_u32 s7, s7, 1
    s_cmp_lt_u32 s7, 0x40000
    s_cbranch_scc1 Lssm_fpoll0
Lssm_fready0:
    buffer_load_dwordx4 v[32:35], v2, s[20:23], s16 offen offset:0 sc1
    buffer_load_dwordx4 v[36:39], v2, s[20:23], s16 offen offset:1024 sc1
    buffer_load_dwordx4 v[40:43], v2, s[20:23], s16 offen offset:2048 sc1
    buffer_load_dwordx4 v[44:47], v2, s[20:23], s16 offen offset:3072 sc1
    s_add_u32 s16, s16, 4096
    buffer_load_dwordx4 v[48:51], v2, s[20:23], s16 offen offset:0 sc1
    buffer_load_dwordx4 v[52:55], v2, s[20:23], s16 offen offset:1024 sc1
    buffer_load_dwordx4 v[56:59], v2, s[20:23], s16 offen offset:2048 sc1
    buffer_load_dwordx4 v[60:63], v2, s[20:23], s16 offen offset:3072 sc1
    s_add_u32 s16, s16, 4096
    buffer_load_dwordx4 v[64:67], v2, s[20:23], s16 offen offset:0 sc1
    buffer_load_dwordx4 v[68:71], v2, s[20:23], s16 offen offset:1024 sc1
    buffer_load_dwordx4 v[72:75], v2, s[20:23], s16 offen offset:2048 sc1
    buffer_load_dwordx4 v[76:79], v2, s[20:23], s16 offen offset:3072 sc1
    s_add_u32 s16, s16, 4096
    buffer_load_dwordx4 v[80:83], v2, s[20:23], s16 offen offset:0 sc1
    buffer_load_dwordx4 v[84:87], v2, s[20:23], s16 offen offset:1024 sc1
    buffer_load_dwordx4 v[88:91], v2, s[20:23], s16 offen offset:2048 sc1
    buffer_load_dwordx4 v[92:95], v2, s[20:23], s16 offen offset:3072 sc1
    s_add_u32 s16, s16, 4096
    buffer_load_dwordx4 v[96:99], v2, s[20:23], s16 offen offset:0 sc1
    buffer_load_dwordx4 v[100:103], v2, s[20:23], s16 offen offset:1024 sc1
    buffer_load_dwordx4 v[104:107], v2, s[20:23], s16 offen offset:2048 sc1
    buffer_load_dwordx4 v[108:111], v2, s[20:23], s16 offen offset:3072 sc1
    s_add_u32 s16, s16, 4096
    buffer_load_dwordx4 v[112:115], v2, s[20:23], s16 offen offset:0 sc1
    buffer_load_dwordx4 v[116:119], v2, s[20:23], s16 offen offset:1024 sc1
    buffer_load_dwordx4 v[120:123], v2, s[20:23], s16 offen offset:2048 sc1
    buffer_load_dwordx4 v[124:127], v2, s[20:23], s16 offen offset:3072 sc1
    v_mfma_f32_32x32x16_bf16 v[156:171], v[240:243], v[128:131], 0
    v_mfma_f32_32x32x16_bf16 v[156:171], v[244:247], v[132:135], v[156:171]
    s_waitcnt vmcnt(23)
    v_mfma_f32_32x32x16_bf16 v[156:171], v[240:243], v[32:35], v[156:171]
    s_waitcnt vmcnt(22)
    v_mfma_f32_32x32x16_bf16 v[156:171], v[244:247], v[36:39], v[156:171]
    s_waitcnt vmcnt(21)
    v_mfma_f32_32x32x16_bf16 v[156:171], v[240:243], v[40:43], v[156:171]
    s_waitcnt vmcnt(20)
    v_mfma_f32_32x32x16_bf16 v[156:171], v[244:247], v[44:47], v[156:171]
    s_waitcnt vmcnt(19)
    v_mfma_f32_32x32x16_bf16 v[156:171], v[240:243], v[48:51], v[156:171]
    s_waitcnt vmcnt(18)
    v_mfma_f32_32x32x16_bf16 v[156:171], v[244:247], v[52:55], v[156:171]
    s_waitcnt vmcnt(17)
    v_mfma_f32_32x32x16_bf16 v[156:171], v[240:243], v[56:59], v[156:171]
    s_waitcnt vmcnt(16)
    v_mfma_f32_32x32x16_bf16 v[156:171], v[244:247], v[60:63], v[156:171]
    s_waitcnt vmcnt(15)
    v_mfma_f32_32x32x16_bf16 v[156:171], v[240:243], v[64:67], v[156:171]
    s_waitcnt vmcnt(14)
    v_mfma_f32_32x32x16_bf16 v[156:171], v[244:247], v[68:71], v[156:171]
    s_waitcnt vmcnt(13)
    v_mfma_f32_32x32x16_bf16 v[156:171], v[240:243], v[72:75], v[156:171]
    s_waitcnt vmcnt(12)
    v_mfma_f32_32x32x16_bf16 v[156:171], v[244:247], v[76:79], v[156:171]
    s_waitcnt vmcnt(11)
    v_mfma_f32_32x32x16_bf16 v[156:171], v[240:243], v[80:83], v[156:171]
    s_waitcnt vmcnt(10)
    v_mfma_f32_32x32x16_bf16 v[156:171], v[244:247], v[84:87], v[156:171]
    s_waitcnt vmcnt(9)
    v_mfma_f32_32x32x16_bf16 v[156:171], v[240:243], v[88:91], v[156:171]
    s_waitcnt vmcnt(8)
    v_mfma_f32_32x32x16_bf16 v[156:171], v[244:247], v[92:95], v[156:171]
    s_waitcnt vmcnt(7)
    v_mfma_f32_32x32x16_bf16 v[156:171], v[240:243], v[96:99], v[156:171]
    s_waitcnt vmcnt(6)
    v_mfma_f32_32x32x16_bf16 v[156:171], v[244:247], v[100:103], v[156:171]
    s_waitcnt vmcnt(5)
    v_mfma_f32_32x32x16_bf16 v[156:171], v[240:243], v[104:107], v[156:171]
    s_waitcnt vmcnt(4)
    v_mfma_f32_32x32x16_bf16 v[156:171], v[244:247], v[108:111], v[156:171]
    s_waitcnt vmcnt(3)
    v_mfma_f32_32x32x16_bf16 v[156:171], v[240:243], v[112:115], v[156:171]
    s_waitcnt vmcnt(2)
    v_mfma_f32_32x32x16_bf16 v[156:171], v[244:247], v[116:119], v[156:171]
    s_waitcnt vmcnt(1)
    v_mfma_f32_32x32x16_bf16 v[156:171], v[240:243], v[120:123], v[156:171]
    s_waitcnt vmcnt(0)
    v_mfma_f32_32x32x16_bf16 v[156:171], v[244:247], v[124:127], v[156:171]
    s_nop 7
    s_nop 3
    v_fma_f32 v156, v156, v24, v184
    v_fma_f32 v157, v157, v24, v185
    v_fma_f32 v158, v158, v24, v186
    v_fma_f32 v159, v159, v24, v187
    v_fma_f32 v160, v160, v24, v188
    v_fma_f32 v161, v161, v24, v189
    v_fma_f32 v162, v162, v24, v190
    v_fma_f32 v163, v163, v24, v191
    v_fma_f32 v164, v164, v24, v192
    v_fma_f32 v165, v165, v24, v193
    v_fma_f32 v166, v166, v24, v194
    v_fma_f32 v167, v167, v24, v195
    v_fma_f32 v168, v168, v24, v196
    v_fma_f32 v169, v169, v24, v197
    v_fma_f32 v170, v170, v24, v198
    v_fma_f32 v171, v171, v24, v199
    v_cvt_pk_bf16_f32 v172, v156, v157
    v_cvt_pk_bf16_f32 v173, v158, v159
    v_cvt_pk_bf16_f32 v174, v160, v161
    v_cvt_pk_bf16_f32 v175, v162, v163
    v_cvt_pk_bf16_f32 v176, v164, v165
    v_cvt_pk_bf16_f32 v177, v166, v167
    v_cvt_pk_bf16_f32 v178, v168, v169
    v_cvt_pk_bf16_f32 v179, v170, v171
    s_nop 1
    v_permlane32_swap_b32 v172, v174
    v_permlane32_swap_b32 v173, v175
    v_permlane32_swap_b32 v176, v178
    v_permlane32_swap_b32 v177, v179
    buffer_store_dwordx4 v[172:175], v6, s[60:63], s24 offen offset:0
    buffer_store_dwordx4 v[176:179], v6, s[60:63], s24 offen offset:32
Lssm_fin:
    s_waitcnt vmcnt(0)
    s_endpgm

.section .rodata,"a"
.p2align 6
.amdhsa_kernel gated_mix__ssm_conv_h3__dense_activation_gelu__prompt_kernel
  .amdhsa_next_free_vgpr 256
  .amdhsa_next_free_sgpr 102
  .amdhsa_accum_offset 256
  .amdhsa_group_segment_fixed_size 0
  .amdhsa_kernarg_size 120
  .amdhsa_user_sgpr_count 2
  .amdhsa_user_sgpr_kernarg_segment_ptr 1
  .amdhsa_system_sgpr_workgroup_id_x 1
.end_amdhsa_kernel
```
